```python
import torch

def _softmax(x, axis=-1):
    return torch.softmax(x, dim=axis)
def _gelu(x):
    return torch.nn.functional.gelu(x, approximate="tanh")
def _silu(x):
    return torch.nn.functional.silu(x)
def _sigmoid(x):
    return torch.sigmoid(x)
def _layernorm(x, axis=-1, eps=1e-5):
    m = x.mean(dim=axis, keepdim=True)
    v = x.var(dim=axis, keepdim=True, unbiased=False)
    return (x - m) / torch.sqrt(v + eps)
def _scatter_add(tgt, idx, src, axis=0):
    return tgt.clone().index_add_(axis, idx, src)
def _segment_sum(src, seg, n):
    out = torch.zeros((n,) + src.shape[1:], dtype=src.dtype)
    return out.index_add_(0, seg, src)
def _pad(x, pw):
    flat = tuple(v for pair in reversed(pw) for v in pair)
    return torch.nn.functional.pad(x, flat)

kernel_name = 'gather_scatter__cheap_equivariant_egnn__graph'

def setup_inputs():

    _w = (lambda a: (lambda t: t.to(torch.bfloat16) if t.is_floating_point() else t)(torch.as_tensor(a)))
    N, deg, D, De = 10000, 16, 128, max(4, 1)
    E = N * deg
    return {
        "h": _w((lambda *s: torch.randn(*s, dtype=torch.bfloat16) * 0.2)(N, D)),
        "pos": _w((lambda *s: torch.randn(*s, dtype=torch.bfloat16) * 0.8)(N, 3)),
        "e_attr": _w((lambda *s: torch.randn(*s, dtype=torch.bfloat16) * 0.8)(E, De)),
        "src": _w((lambda lo, hi, *s: torch.randint(lo, hi, s))(0, N, E).to(torch.int64)),
        "dst": _w((lambda lo, hi, *s: torch.randint(lo, hi, s))(0, N, E).to(torch.int64)),
        "w_e": _w(0.1 * (lambda *s: torch.randn(*s, dtype=torch.bfloat16) * 0.8)(2 * D + 1 + De, D)),
        "w_x": _w(0.1 * (lambda *s: torch.randn(*s, dtype=torch.bfloat16) * 0.2)(D, 1)),
        "w_h": _w(0.1 * (lambda *s: torch.randn(*s, dtype=torch.bfloat16) * 0.2)(2 * D, D)),
    }

def reference(h, pos, e_attr, src, dst, w_e, w_x, w_h):
    N, D = h.shape[0], h.shape[1]
    diff = pos[dst] - pos[src]
    dist2 = torch.sum(diff * diff, axis=-1, keepdims=True)
    e_in = torch.concatenate([h[dst], h[src], dist2, e_attr], axis=-1)
    m_ij = _silu(e_in @ w_e)
    coord_scale = m_ij @ w_x
    pos_new = pos + _segment_sum(diff * coord_scale, dst, N)
    m_i = _segment_sum(m_ij, dst, N)
    h_new = h + _silu(torch.concatenate([h, m_i], axis=-1) @ w_h)
    return h_new, pos_new
```

```asm
; @launch kernel=ka_kernel grid=(377,1,1) block=(256,1,1) lds=65536
; @launch kernel=kb_kernel grid=(1250,1,1) block=(256,1,1) lds=27136
; @launch kernel=kc_kernel grid=(313,1,1) block=(256,1,1) lds=65536
.amdgcn_target "amdgcn-amd-amdhsa--gfx950"
.text
.globl ka_kernel
.p2align 8
.type ka_kernel,@function
ka_kernel:
s_load_dwordx16 s[4:19], s[0:1], 0
s_load_dwordx4 s[20:23], s[0:1], 64
s_load_dwordx2 s[24:25], s[0:1], 80
s_waitcnt lgkmcnt(0)
s_cmp_ge_u32 s2, 313
s_cbranch_scc1 ka_sort
s_mov_b32 s28, s4
s_mov_b32 s29, s5
s_mov_b32 s30, 2560000
s_mov_b32 s31, 0x00020000
s_mov_b32 s36, s14
s_mov_b32 s37, s15
s_mov_b32 s38, 66816
s_mov_b32 s39, 0x00020000
s_add_u32 s40, s24, 0
s_addc_u32 s41, s25, 0
s_mov_b32 s42, 10240000
s_mov_b32 s43, 0x00020000
v_and_b32 v1, 63, v0
v_lshrrev_b32 v2, 6, v0
v_and_b32 v3, 31, v1
v_lshrrev_b32 v4, 5, v1
s_lshl_b32 s3, s2, 5
v_add_u32 v5, s3, v3
v_lshlrev_b32 v6, 8, v5
v_lshl_add_u32 v6, v4, 4, v6
v_lshl_add_u32 v10, v2, 6, v3
v_add_u32 v10, 0, v10
v_lshrrev_b32 v12, 7, v10
v_lshlrev_b32 v12, 15, v12
v_lshl_add_u32 v12, v4, 11, v12
v_and_b32 v7, 127, v10
v_lshl_add_u32 v12, v7, 1, v12
v_lshl_add_u32 v11, v2, 6, v3
v_add_u32 v11, 32, v11
v_lshrrev_b32 v13, 7, v11
v_lshlrev_b32 v13, 15, v13
v_lshl_add_u32 v13, v4, 11, v13
v_and_b32 v7, 127, v11
v_lshl_add_u32 v13, v7, 1, v13
v_mov_b32 v16, 0
v_mov_b32 v17, 0
v_mov_b32 v18, 0
v_mov_b32 v19, 0
v_mov_b32 v20, 0
v_mov_b32 v21, 0
v_mov_b32 v22, 0
v_mov_b32 v23, 0
v_mov_b32 v24, 0
v_mov_b32 v25, 0
v_mov_b32 v26, 0
v_mov_b32 v27, 0
v_mov_b32 v28, 0
v_mov_b32 v29, 0
v_mov_b32 v30, 0
v_mov_b32 v31, 0
v_mov_b32 v32, 0
v_mov_b32 v33, 0
v_mov_b32 v34, 0
v_mov_b32 v35, 0
v_mov_b32 v36, 0
v_mov_b32 v37, 0
v_mov_b32 v38, 0
v_mov_b32 v39, 0
v_mov_b32 v40, 0
v_mov_b32 v41, 0
v_mov_b32 v42, 0
v_mov_b32 v43, 0
v_mov_b32 v44, 0
v_mov_b32 v45, 0
v_mov_b32 v46, 0
v_mov_b32 v47, 0
buffer_load_dwordx4 v[48:51], v6, s[28:31], 0 offen offset:0
buffer_load_dwordx4 v[52:55], v6, s[28:31], 0 offen offset:32
buffer_load_dwordx4 v[56:59], v6, s[28:31], 0 offen offset:64
buffer_load_dwordx4 v[60:63], v6, s[28:31], 0 offen offset:96
buffer_load_dwordx4 v[64:67], v6, s[28:31], 0 offen offset:128
buffer_load_dwordx4 v[68:71], v6, s[28:31], 0 offen offset:160
buffer_load_dwordx4 v[72:75], v6, s[28:31], 0 offen offset:192
buffer_load_dwordx4 v[76:79], v6, s[28:31], 0 offen offset:224
v_lshlrev_b32 v8, 4, v0
s_mov_b32 s44, 0
buffer_load_dwordx4 v[112:115], v8, s[36:39], s44 offen
s_mov_b32 s44, 4096
buffer_load_dwordx4 v[116:119], v8, s[36:39], s44 offen
s_mov_b32 s44, 8192
buffer_load_dwordx4 v[120:123], v8, s[36:39], s44 offen
s_mov_b32 s44, 12288
buffer_load_dwordx4 v[124:127], v8, s[36:39], s44 offen
s_mov_b32 s44, 16384
buffer_load_dwordx4 v[128:131], v8, s[36:39], s44 offen
s_mov_b32 s44, 20480
buffer_load_dwordx4 v[132:135], v8, s[36:39], s44 offen
s_mov_b32 s44, 24576
buffer_load_dwordx4 v[136:139], v8, s[36:39], s44 offen
s_mov_b32 s44, 28672
buffer_load_dwordx4 v[140:143], v8, s[36:39], s44 offen
s_mov_b32 s44, 32768
buffer_load_dwordx4 v[144:147], v8, s[36:39], s44 offen
s_mov_b32 s44, 36864
buffer_load_dwordx4 v[148:151], v8, s[36:39], s44 offen
s_mov_b32 s44, 40960
buffer_load_dwordx4 v[152:155], v8, s[36:39], s44 offen
s_mov_b32 s44, 45056
buffer_load_dwordx4 v[156:159], v8, s[36:39], s44 offen
s_mov_b32 s44, 49152
buffer_load_dwordx4 v[160:163], v8, s[36:39], s44 offen
s_mov_b32 s44, 53248
buffer_load_dwordx4 v[164:167], v8, s[36:39], s44 offen
s_mov_b32 s44, 57344
buffer_load_dwordx4 v[168:171], v8, s[36:39], s44 offen
s_mov_b32 s44, 61440
buffer_load_dwordx4 v[172:175], v8, s[36:39], s44 offen
s_waitcnt vmcnt(0)
ds_write_b128 v8, v[112:115] offset:0
ds_write_b128 v8, v[116:119] offset:4096
ds_write_b128 v8, v[120:123] offset:8192
ds_write_b128 v8, v[124:127] offset:12288
ds_write_b128 v8, v[128:131] offset:16384
ds_write_b128 v8, v[132:135] offset:20480
ds_write_b128 v8, v[136:139] offset:24576
ds_write_b128 v8, v[140:143] offset:28672
ds_write_b128 v8, v[144:147] offset:32768
ds_write_b128 v8, v[148:151] offset:36864
ds_write_b128 v8, v[152:155] offset:40960
ds_write_b128 v8, v[156:159] offset:45056
ds_write_b128 v8, v[160:163] offset:49152
ds_write_b128 v8, v[164:167] offset:53248
ds_write_b128 v8, v[168:171] offset:57344
ds_write_b128 v8, v[172:175] offset:61440
v_bfe_u32 v9, v1, 2, 2
v_lshl_add_u32 v9, v4, 3, v9
v_lshlrev_b32 v9, 8, v9
v_bfe_u32 v14, v1, 4, 1
v_lshl_add_u32 v9, v14, 5, v9
v_and_b32 v14, 3, v1
v_lshl_add_u32 v9, v14, 3, v9
s_waitcnt lgkmcnt(0)
s_barrier
v_and_b32 v14, 1, v2
v_lshl_add_u32 v8, v14, 7, v9
v_add_u32 v8, 0, v8
v_lshrrev_b32 v14, 1, v2
v_lshl_add_u32 v8, v14, 15, v8
ds_read_b64_tr_b16 v[112:113], v8 offset:0
ds_read_b64_tr_b16 v[114:115], v8 offset:1024
ds_read_b64_tr_b16 v[116:117], v8 offset:4096
ds_read_b64_tr_b16 v[118:119], v8 offset:5120
ds_read_b64_tr_b16 v[120:121], v8 offset:8192
ds_read_b64_tr_b16 v[122:123], v8 offset:9216
ds_read_b64_tr_b16 v[124:125], v8 offset:12288
ds_read_b64_tr_b16 v[126:127], v8 offset:13312
ds_read_b64_tr_b16 v[128:129], v8 offset:16384
ds_read_b64_tr_b16 v[130:131], v8 offset:17408
ds_read_b64_tr_b16 v[132:133], v8 offset:20480
ds_read_b64_tr_b16 v[134:135], v8 offset:21504
ds_read_b64_tr_b16 v[136:137], v8 offset:24576
ds_read_b64_tr_b16 v[138:139], v8 offset:25600
ds_read_b64_tr_b16 v[140:141], v8 offset:28672
ds_read_b64_tr_b16 v[142:143], v8 offset:29696
s_waitcnt vmcnt(0) lgkmcnt(0)
v_mfma_f32_32x32x16_bf16 v[16:31], v[48:51], v[112:115], v[16:31]
v_mfma_f32_32x32x16_bf16 v[16:31], v[52:55], v[116:119], v[16:31]
v_mfma_f32_32x32x16_bf16 v[16:31], v[56:59], v[120:123], v[16:31]
v_mfma_f32_32x32x16_bf16 v[16:31], v[60:63], v[124:127], v[16:31]
v_mfma_f32_32x32x16_bf16 v[16:31], v[64:67], v[128:131], v[16:31]
v_mfma_f32_32x32x16_bf16 v[16:31], v[68:71], v[132:135], v[16:31]
v_mfma_f32_32x32x16_bf16 v[16:31], v[72:75], v[136:139], v[16:31]
v_mfma_f32_32x32x16_bf16 v[16:31], v[76:79], v[140:143], v[16:31]
s_nop 15
v_and_b32 v14, 1, v2
v_lshl_add_u32 v8, v14, 7, v9
v_add_u32 v8, 64, v8
v_lshrrev_b32 v14, 1, v2
v_lshl_add_u32 v8, v14, 15, v8
ds_read_b64_tr_b16 v[112:113], v8 offset:0
ds_read_b64_tr_b16 v[114:115], v8 offset:1024
ds_read_b64_tr_b16 v[116:117], v8 offset:4096
ds_read_b64_tr_b16 v[118:119], v8 offset:5120
ds_read_b64_tr_b16 v[120:121], v8 offset:8192
ds_read_b64_tr_b16 v[122:123], v8 offset:9216
ds_read_b64_tr_b16 v[124:125], v8 offset:12288
ds_read_b64_tr_b16 v[126:127], v8 offset:13312
ds_read_b64_tr_b16 v[128:129], v8 offset:16384
ds_read_b64_tr_b16 v[130:131], v8 offset:17408
ds_read_b64_tr_b16 v[132:133], v8 offset:20480
ds_read_b64_tr_b16 v[134:135], v8 offset:21504
ds_read_b64_tr_b16 v[136:137], v8 offset:24576
ds_read_b64_tr_b16 v[138:139], v8 offset:25600
ds_read_b64_tr_b16 v[140:141], v8 offset:28672
ds_read_b64_tr_b16 v[142:143], v8 offset:29696
s_waitcnt vmcnt(0) lgkmcnt(0)
v_mfma_f32_32x32x16_bf16 v[32:47], v[48:51], v[112:115], v[32:47]
v_mfma_f32_32x32x16_bf16 v[32:47], v[52:55], v[116:119], v[32:47]
v_mfma_f32_32x32x16_bf16 v[32:47], v[56:59], v[120:123], v[32:47]
v_mfma_f32_32x32x16_bf16 v[32:47], v[60:63], v[124:127], v[32:47]
v_mfma_f32_32x32x16_bf16 v[32:47], v[64:67], v[128:131], v[32:47]
v_mfma_f32_32x32x16_bf16 v[32:47], v[68:71], v[132:135], v[32:47]
v_mfma_f32_32x32x16_bf16 v[32:47], v[72:75], v[136:139], v[32:47]
v_mfma_f32_32x32x16_bf16 v[32:47], v[76:79], v[140:143], v[32:47]
s_nop 15
s_nop 15
v_lshl_add_u32 v8, v4, 2, 0
v_add_u32 v8, s3, v8
v_lshlrev_b32 v8, 10, v8
v_lshl_add_u32 v8, v10, 2, v8
buffer_store_dword v16, v8, s[40:43], 0 offen
v_lshl_add_u32 v8, v4, 2, 1
v_add_u32 v8, s3, v8
v_lshlrev_b32 v8, 10, v8
v_lshl_add_u32 v8, v10, 2, v8
buffer_store_dword v17, v8, s[40:43], 0 offen
v_lshl_add_u32 v8, v4, 2, 2
v_add_u32 v8, s3, v8
v_lshlrev_b32 v8, 10, v8
v_lshl_add_u32 v8, v10, 2, v8
buffer_store_dword v18, v8, s[40:43], 0 offen
v_lshl_add_u32 v8, v4, 2, 3
v_add_u32 v8, s3, v8
v_lshlrev_b32 v8, 10, v8
v_lshl_add_u32 v8, v10, 2, v8
buffer_store_dword v19, v8, s[40:43], 0 offen
v_lshl_add_u32 v8, v4, 2, 8
v_add_u32 v8, s3, v8
v_lshlrev_b32 v8, 10, v8
v_lshl_add_u32 v8, v10, 2, v8
buffer_store_dword v20, v8, s[40:43], 0 offen
v_lshl_add_u32 v8, v4, 2, 9
v_add_u32 v8, s3, v8
v_lshlrev_b32 v8, 10, v8
v_lshl_add_u32 v8, v10, 2, v8
buffer_store_dword v21, v8, s[40:43], 0 offen
v_lshl_add_u32 v8, v4, 2, 10
v_add_u32 v8, s3, v8
v_lshlrev_b32 v8, 10, v8
v_lshl_add_u32 v8, v10, 2, v8
buffer_store_dword v22, v8, s[40:43], 0 offen
v_lshl_add_u32 v8, v4, 2, 11
v_add_u32 v8, s3, v8
v_lshlrev_b32 v8, 10, v8
v_lshl_add_u32 v8, v10, 2, v8
buffer_store_dword v23, v8, s[40:43], 0 offen
v_lshl_add_u32 v8, v4, 2, 16
v_add_u32 v8, s3, v8
v_lshlrev_b32 v8, 10, v8
v_lshl_add_u32 v8, v10, 2, v8
buffer_store_dword v24, v8, s[40:43], 0 offen
v_lshl_add_u32 v8, v4, 2, 17
v_add_u32 v8, s3, v8
v_lshlrev_b32 v8, 10, v8
v_lshl_add_u32 v8, v10, 2, v8
buffer_store_dword v25, v8, s[40:43], 0 offen
v_lshl_add_u32 v8, v4, 2, 18
v_add_u32 v8, s3, v8
v_lshlrev_b32 v8, 10, v8
v_lshl_add_u32 v8, v10, 2, v8
buffer_store_dword v26, v8, s[40:43], 0 offen
v_lshl_add_u32 v8, v4, 2, 19
v_add_u32 v8, s3, v8
v_lshlrev_b32 v8, 10, v8
v_lshl_add_u32 v8, v10, 2, v8
buffer_store_dword v27, v8, s[40:43], 0 offen
v_lshl_add_u32 v8, v4, 2, 24
v_add_u32 v8, s3, v8
v_lshlrev_b32 v8, 10, v8
v_lshl_add_u32 v8, v10, 2, v8
buffer_store_dword v28, v8, s[40:43], 0 offen
v_lshl_add_u32 v8, v4, 2, 25
v_add_u32 v8, s3, v8
v_lshlrev_b32 v8, 10, v8
v_lshl_add_u32 v8, v10, 2, v8
buffer_store_dword v29, v8, s[40:43], 0 offen
v_lshl_add_u32 v8, v4, 2, 26
v_add_u32 v8, s3, v8
v_lshlrev_b32 v8, 10, v8
v_lshl_add_u32 v8, v10, 2, v8
buffer_store_dword v30, v8, s[40:43], 0 offen
v_lshl_add_u32 v8, v4, 2, 27
v_add_u32 v8, s3, v8
v_lshlrev_b32 v8, 10, v8
v_lshl_add_u32 v8, v10, 2, v8
buffer_store_dword v31, v8, s[40:43], 0 offen
v_lshl_add_u32 v8, v4, 2, 0
v_add_u32 v8, s3, v8
v_lshlrev_b32 v8, 10, v8
v_lshl_add_u32 v8, v11, 2, v8
buffer_store_dword v32, v8, s[40:43], 0 offen
v_lshl_add_u32 v8, v4, 2, 1
v_add_u32 v8, s3, v8
v_lshlrev_b32 v8, 10, v8
v_lshl_add_u32 v8, v11, 2, v8
buffer_store_dword v33, v8, s[40:43], 0 offen
v_lshl_add_u32 v8, v4, 2, 2
v_add_u32 v8, s3, v8
v_lshlrev_b32 v8, 10, v8
v_lshl_add_u32 v8, v11, 2, v8
buffer_store_dword v34, v8, s[40:43], 0 offen
v_lshl_add_u32 v8, v4, 2, 3
v_add_u32 v8, s3, v8
v_lshlrev_b32 v8, 10, v8
v_lshl_add_u32 v8, v11, 2, v8
buffer_store_dword v35, v8, s[40:43], 0 offen
v_lshl_add_u32 v8, v4, 2, 8
v_add_u32 v8, s3, v8
v_lshlrev_b32 v8, 10, v8
v_lshl_add_u32 v8, v11, 2, v8
buffer_store_dword v36, v8, s[40:43], 0 offen
v_lshl_add_u32 v8, v4, 2, 9
v_add_u32 v8, s3, v8
v_lshlrev_b32 v8, 10, v8
v_lshl_add_u32 v8, v11, 2, v8
buffer_store_dword v37, v8, s[40:43], 0 offen
v_lshl_add_u32 v8, v4, 2, 10
v_add_u32 v8, s3, v8
v_lshlrev_b32 v8, 10, v8
v_lshl_add_u32 v8, v11, 2, v8
buffer_store_dword v38, v8, s[40:43], 0 offen
v_lshl_add_u32 v8, v4, 2, 11
v_add_u32 v8, s3, v8
v_lshlrev_b32 v8, 10, v8
v_lshl_add_u32 v8, v11, 2, v8
buffer_store_dword v39, v8, s[40:43], 0 offen
v_lshl_add_u32 v8, v4, 2, 16
v_add_u32 v8, s3, v8
v_lshlrev_b32 v8, 10, v8
v_lshl_add_u32 v8, v11, 2, v8
buffer_store_dword v40, v8, s[40:43], 0 offen
v_lshl_add_u32 v8, v4, 2, 17
v_add_u32 v8, s3, v8
v_lshlrev_b32 v8, 10, v8
v_lshl_add_u32 v8, v11, 2, v8
buffer_store_dword v41, v8, s[40:43], 0 offen
v_lshl_add_u32 v8, v4, 2, 18
v_add_u32 v8, s3, v8
v_lshlrev_b32 v8, 10, v8
v_lshl_add_u32 v8, v11, 2, v8
buffer_store_dword v42, v8, s[40:43], 0 offen
v_lshl_add_u32 v8, v4, 2, 19
v_add_u32 v8, s3, v8
v_lshlrev_b32 v8, 10, v8
v_lshl_add_u32 v8, v11, 2, v8
buffer_store_dword v43, v8, s[40:43], 0 offen
v_lshl_add_u32 v8, v4, 2, 24
v_add_u32 v8, s3, v8
v_lshlrev_b32 v8, 10, v8
v_lshl_add_u32 v8, v11, 2, v8
buffer_store_dword v44, v8, s[40:43], 0 offen
v_lshl_add_u32 v8, v4, 2, 25
v_add_u32 v8, s3, v8
v_lshlrev_b32 v8, 10, v8
v_lshl_add_u32 v8, v11, 2, v8
buffer_store_dword v45, v8, s[40:43], 0 offen
v_lshl_add_u32 v8, v4, 2, 26
v_add_u32 v8, s3, v8
v_lshlrev_b32 v8, 10, v8
v_lshl_add_u32 v8, v11, 2, v8
buffer_store_dword v46, v8, s[40:43], 0 offen
v_lshl_add_u32 v8, v4, 2, 27
v_add_u32 v8, s3, v8
v_lshlrev_b32 v8, 10, v8
v_lshl_add_u32 v8, v11, 2, v8
buffer_store_dword v47, v8, s[40:43], 0 offen
s_endpgm
ka_sort:
s_sub_u32 s26, s2, 313
s_cmp_ge_u32 s26, 64
s_cbranch_scc1 ka_end
s_mov_b32 s28, s12
s_mov_b32 s29, s13
s_mov_b32 s30, 640000
s_mov_b32 s31, 0x00020000
s_add_u32 s32, s24, 10485760
s_addc_u32 s33, s25, 0
s_mov_b32 s34, 320256
s_mov_b32 s35, 0x00020000
s_add_u32 s36, s24, 11534336
s_addc_u32 s37, s25, 0
s_mov_b32 s38, 2560000
s_mov_b32 s39, 0x00020000
s_mov_b32 s44, s10
s_mov_b32 s45, s11
s_mov_b32 s46, 640000
s_mov_b32 s47, 0x00020000
s_mov_b32 s48, s8
s_mov_b32 s49, s9
s_mov_b32 s50, 1280000
s_mov_b32 s51, 0x00020000
v_mov_b32 v1, 0
v_mul_u32_u24 v2, 20, v0
ds_write_b32 v2, v1 offset:0
ds_write_b32 v2, v1 offset:4
ds_write_b32 v2, v1 offset:8
ds_write_b32 v2, v1 offset:12
ds_write_b32 v2, v1 offset:16
s_mul_i32 s27, s26, 2500
v_add_u32 v3, s27, v0
v_lshlrev_b32 v4, 2, v3
buffer_load_dword v10, v4, s[28:31], 0 offen offset:0
v_add_u32 v5, 0, v4
buffer_load_dword v50, v5, s[44:47], 0 offen
buffer_load_dword v51, v5, s[28:31], 0 offen
v_lshlrev_b32 v5, 1, v5
buffer_load_dwordx2 v[52:53], v5, s[48:51], 0 offen
buffer_load_dword v11, v4, s[28:31], 0 offen offset:1024
v_add_u32 v5, 1024, v4
buffer_load_dword v54, v5, s[44:47], 0 offen
buffer_load_dword v55, v5, s[28:31], 0 offen
v_lshlrev_b32 v5, 1, v5
buffer_load_dwordx2 v[56:57], v5, s[48:51], 0 offen
buffer_load_dword v12, v4, s[28:31], 0 offen offset:2048
v_add_u32 v5, 2048, v4
buffer_load_dword v58, v5, s[44:47], 0 offen
buffer_load_dword v59, v5, s[28:31], 0 offen
v_lshlrev_b32 v5, 1, v5
buffer_load_dwordx2 v[60:61], v5, s[48:51], 0 offen
buffer_load_dword v13, v4, s[28:31], 0 offen offset:3072
v_add_u32 v5, 3072, v4
buffer_load_dword v62, v5, s[44:47], 0 offen
buffer_load_dword v63, v5, s[28:31], 0 offen
v_lshlrev_b32 v5, 1, v5
buffer_load_dwordx2 v[64:65], v5, s[48:51], 0 offen
v_add_u32 v5, 4096, v4
buffer_load_dword v14, v5, s[28:31], 0 offen
v_add_u32 v5, 4096, v4
buffer_load_dword v66, v5, s[44:47], 0 offen
buffer_load_dword v67, v5, s[28:31], 0 offen
v_lshlrev_b32 v5, 1, v5
buffer_load_dwordx2 v[68:69], v5, s[48:51], 0 offen
v_add_u32 v5, 5120, v4
buffer_load_dword v15, v5, s[28:31], 0 offen
v_add_u32 v5, 5120, v4
buffer_load_dword v70, v5, s[44:47], 0 offen
buffer_load_dword v71, v5, s[28:31], 0 offen
v_lshlrev_b32 v5, 1, v5
buffer_load_dwordx2 v[72:73], v5, s[48:51], 0 offen
v_add_u32 v5, 6144, v4
buffer_load_dword v16, v5, s[28:31], 0 offen
v_add_u32 v5, 6144, v4
buffer_load_dword v74, v5, s[44:47], 0 offen
buffer_load_dword v75, v5, s[28:31], 0 offen
v_lshlrev_b32 v5, 1, v5
buffer_load_dwordx2 v[76:77], v5, s[48:51], 0 offen
v_add_u32 v5, 7168, v4
buffer_load_dword v17, v5, s[28:31], 0 offen
v_add_u32 v5, 7168, v4
buffer_load_dword v78, v5, s[44:47], 0 offen
buffer_load_dword v79, v5, s[28:31], 0 offen
v_lshlrev_b32 v5, 1, v5
buffer_load_dwordx2 v[80:81], v5, s[48:51], 0 offen
v_add_u32 v5, 8192, v4
buffer_load_dword v18, v5, s[28:31], 0 offen
v_add_u32 v5, 8192, v4
buffer_load_dword v82, v5, s[44:47], 0 offen
buffer_load_dword v83, v5, s[28:31], 0 offen
v_lshlrev_b32 v5, 1, v5
buffer_load_dwordx2 v[84:85], v5, s[48:51], 0 offen
v_cmp_gt_u32 vcc, 196, v0
s_and_saveexec_b64 s[40:41], vcc
v_add_u32 v5, 9216, v4
buffer_load_dword v19, v5, s[28:31], 0 offen
v_add_u32 v5, 9216, v4
buffer_load_dword v86, v5, s[44:47], 0 offen
buffer_load_dword v87, v5, s[28:31], 0 offen
v_lshlrev_b32 v5, 1, v5
buffer_load_dwordx2 v[88:89], v5, s[48:51], 0 offen
s_mov_b64 exec, -1
s_waitcnt vmcnt(0) lgkmcnt(0)
s_barrier
v_mov_b32 v1, 1
v_lshrrev_b32 v10, 3, v10
v_lshlrev_b32 v10, 2, v10
ds_add_rtn_u32 v20, v10, v1
v_lshrrev_b32 v11, 3, v11
v_lshlrev_b32 v11, 2, v11
ds_add_rtn_u32 v21, v11, v1
v_lshrrev_b32 v12, 3, v12
v_lshlrev_b32 v12, 2, v12
ds_add_rtn_u32 v22, v12, v1
v_lshrrev_b32 v13, 3, v13
v_lshlrev_b32 v13, 2, v13
ds_add_rtn_u32 v23, v13, v1
v_lshrrev_b32 v14, 3, v14
v_lshlrev_b32 v14, 2, v14
ds_add_rtn_u32 v24, v14, v1
v_lshrrev_b32 v15, 3, v15
v_lshlrev_b32 v15, 2, v15
ds_add_rtn_u32 v25, v15, v1
v_lshrrev_b32 v16, 3, v16
v_lshlrev_b32 v16, 2, v16
ds_add_rtn_u32 v26, v16, v1
v_lshrrev_b32 v17, 3, v17
v_lshlrev_b32 v17, 2, v17
ds_add_rtn_u32 v27, v17, v1
v_lshrrev_b32 v18, 3, v18
v_lshlrev_b32 v18, 2, v18
ds_add_rtn_u32 v28, v18, v1
s_mov_b64 exec, s[40:41]
v_cmp_gt_u32 vcc, 196, v0
s_and_saveexec_b64 s[40:41], vcc
v_lshrrev_b32 v19, 3, v19
v_lshlrev_b32 v19, 2, v19
ds_add_rtn_u32 v29, v19, v1
s_mov_b64 exec, -1
s_waitcnt lgkmcnt(0)
s_barrier
ds_read_b32 v30, v2 offset:0
ds_read_b32 v31, v2 offset:4
ds_read_b32 v32, v2 offset:8
ds_read_b32 v33, v2 offset:12
ds_read_b32 v34, v2 offset:16
s_waitcnt lgkmcnt(0)
v_add_u32 v35, v30, v31
v_add_u32 v35, v35, v32
v_add_u32 v35, v35, v33
v_add_u32 v35, v35, v34
v_lshlrev_b32 v6, 2, v0
v_mov_b32 v36, v35
ds_write_b32 v6, v36 offset:5120
s_waitcnt lgkmcnt(0)
s_barrier
v_subrev_u32 v7, 4, v6
v_max_i32 v7, 0, v7
ds_read_b32 v8, v7 offset:5120
s_waitcnt lgkmcnt(0)
s_barrier
v_cmp_le_u32 vcc, 1, v0
s_nop 1
v_cndmask_b32 v8, 0, v8, vcc
v_add_u32 v36, v36, v8
ds_write_b32 v6, v36 offset:5120
s_waitcnt lgkmcnt(0)
s_barrier
v_subrev_u32 v7, 8, v6
v_max_i32 v7, 0, v7
ds_read_b32 v8, v7 offset:5120
s_waitcnt lgkmcnt(0)
s_barrier
v_cmp_le_u32 vcc, 2, v0
s_nop 1
v_cndmask_b32 v8, 0, v8, vcc
v_add_u32 v36, v36, v8
ds_write_b32 v6, v36 offset:5120
s_waitcnt lgkmcnt(0)
s_barrier
v_subrev_u32 v7, 16, v6
v_max_i32 v7, 0, v7
ds_read_b32 v8, v7 offset:5120
s_waitcnt lgkmcnt(0)
s_barrier
v_cmp_le_u32 vcc, 4, v0
s_nop 1
v_cndmask_b32 v8, 0, v8, vcc
v_add_u32 v36, v36, v8
ds_write_b32 v6, v36 offset:5120
s_waitcnt lgkmcnt(0)
s_barrier
v_subrev_u32 v7, 32, v6
v_max_i32 v7, 0, v7
ds_read_b32 v8, v7 offset:5120
s_waitcnt lgkmcnt(0)
s_barrier
v_cmp_le_u32 vcc, 8, v0
s_nop 1
v_cndmask_b32 v8, 0, v8, vcc
v_add_u32 v36, v36, v8
ds_write_b32 v6, v36 offset:5120
s_waitcnt lgkmcnt(0)
s_barrier
v_subrev_u32 v7, 64, v6
v_max_i32 v7, 0, v7
ds_read_b32 v8, v7 offset:5120
s_waitcnt lgkmcnt(0)
s_barrier
v_cmp_le_u32 vcc, 16, v0
s_nop 1
v_cndmask_b32 v8, 0, v8, vcc
v_add_u32 v36, v36, v8
ds_write_b32 v6, v36 offset:5120
s_waitcnt lgkmcnt(0)
s_barrier
v_subrev_u32 v7, 128, v6
v_max_i32 v7, 0, v7
ds_read_b32 v8, v7 offset:5120
s_waitcnt lgkmcnt(0)
s_barrier
v_cmp_le_u32 vcc, 32, v0
s_nop 1
v_cndmask_b32 v8, 0, v8, vcc
v_add_u32 v36, v36, v8
ds_write_b32 v6, v36 offset:5120
s_waitcnt lgkmcnt(0)
s_barrier
v_subrev_u32 v7, 256, v6
v_max_i32 v7, 0, v7
ds_read_b32 v8, v7 offset:5120
s_waitcnt lgkmcnt(0)
s_barrier
v_cmp_le_u32 vcc, 64, v0
s_nop 1
v_cndmask_b32 v8, 0, v8, vcc
v_add_u32 v36, v36, v8
ds_write_b32 v6, v36 offset:5120
s_waitcnt lgkmcnt(0)
s_barrier
v_subrev_u32 v7, 512, v6
v_max_i32 v7, 0, v7
ds_read_b32 v8, v7 offset:5120
s_waitcnt lgkmcnt(0)
s_barrier
v_cmp_le_u32 vcc, 128, v0
s_nop 1
v_cndmask_b32 v8, 0, v8, vcc
v_add_u32 v36, v36, v8
v_sub_u32 v36, v36, v35
s_lshl_b32 s27, s26, 2
v_mul_u32_u24 v7, 1280, v0
v_add_u32 v7, s27, v7
ds_write_b32 v2, v36 offset:0
buffer_store_dword v36, v7, s[32:35], 0 offen offset:0
v_add_u32 v36, v36, v30
ds_write_b32 v2, v36 offset:4
buffer_store_dword v36, v7, s[32:35], 0 offen offset:256
v_add_u32 v36, v36, v31
ds_write_b32 v2, v36 offset:8
buffer_store_dword v36, v7, s[32:35], 0 offen offset:512
v_add_u32 v36, v36, v32
ds_write_b32 v2, v36 offset:12
buffer_store_dword v36, v7, s[32:35], 0 offen offset:768
v_add_u32 v36, v36, v33
ds_write_b32 v2, v36 offset:16
buffer_store_dword v36, v7, s[32:35], 0 offen offset:1024
v_add_u32 v36, v36, v34
s_waitcnt lgkmcnt(0)
s_barrier
ds_read_b32 v8, v10
s_waitcnt lgkmcnt(0)
v_add_u32 v8, v8, v20
s_mul_i32 s27, s26, 2500
v_add_u32 v8, s27, v8
v_lshlrev_b32 v8, 4, v8
buffer_store_dwordx4 v[50:53], v8, s[36:39], 0 offen
ds_read_b32 v8, v11
s_waitcnt lgkmcnt(0)
v_add_u32 v8, v8, v21
s_mul_i32 s27, s26, 2500
v_add_u32 v8, s27, v8
v_lshlrev_b32 v8, 4, v8
buffer_store_dwordx4 v[54:57], v8, s[36:39], 0 offen
ds_read_b32 v8, v12
s_waitcnt lgkmcnt(0)
v_add_u32 v8, v8, v22
s_mul_i32 s27, s26, 2500
v_add_u32 v8, s27, v8
v_lshlrev_b32 v8, 4, v8
buffer_store_dwordx4 v[58:61], v8, s[36:39], 0 offen
ds_read_b32 v8, v13
s_waitcnt lgkmcnt(0)
v_add_u32 v8, v8, v23
s_mul_i32 s27, s26, 2500
v_add_u32 v8, s27, v8
v_lshlrev_b32 v8, 4, v8
buffer_store_dwordx4 v[62:65], v8, s[36:39], 0 offen
ds_read_b32 v8, v14
s_waitcnt lgkmcnt(0)
v_add_u32 v8, v8, v24
s_mul_i32 s27, s26, 2500
v_add_u32 v8, s27, v8
v_lshlrev_b32 v8, 4, v8
buffer_store_dwordx4 v[66:69], v8, s[36:39], 0 offen
ds_read_b32 v8, v15
s_waitcnt lgkmcnt(0)
v_add_u32 v8, v8, v25
s_mul_i32 s27, s26, 2500
v_add_u32 v8, s27, v8
v_lshlrev_b32 v8, 4, v8
buffer_store_dwordx4 v[70:73], v8, s[36:39], 0 offen
ds_read_b32 v8, v16
s_waitcnt lgkmcnt(0)
v_add_u32 v8, v8, v26
s_mul_i32 s27, s26, 2500
v_add_u32 v8, s27, v8
v_lshlrev_b32 v8, 4, v8
buffer_store_dwordx4 v[74:77], v8, s[36:39], 0 offen
ds_read_b32 v8, v17
s_waitcnt lgkmcnt(0)
v_add_u32 v8, v8, v27
s_mul_i32 s27, s26, 2500
v_add_u32 v8, s27, v8
v_lshlrev_b32 v8, 4, v8
buffer_store_dwordx4 v[78:81], v8, s[36:39], 0 offen
ds_read_b32 v8, v18
s_waitcnt lgkmcnt(0)
v_add_u32 v8, v8, v28
s_mul_i32 s27, s26, 2500
v_add_u32 v8, s27, v8
v_lshlrev_b32 v8, 4, v8
buffer_store_dwordx4 v[82:85], v8, s[36:39], 0 offen
v_cmp_gt_u32 vcc, 196, v0
s_and_saveexec_b64 s[40:41], vcc
ds_read_b32 v8, v19
s_waitcnt lgkmcnt(0)
v_add_u32 v8, v8, v29
s_mul_i32 s27, s26, 2500
v_add_u32 v8, s27, v8
v_lshlrev_b32 v8, 4, v8
buffer_store_dwordx4 v[86:89], v8, s[36:39], 0 offen
ka_end:
s_endpgm
.globl kb_kernel
.p2align 8
.type kb_kernel,@function
kb_kernel:
s_load_dwordx16 s[4:19], s[0:1], 0
s_load_dwordx4 s[20:23], s[0:1], 64
s_load_dwordx2 s[24:25], s[0:1], 80
s_waitcnt lgkmcnt(0)
s_cmp_ge_u32 s2, 1250
s_cbranch_scc1 kb_end
s_mov_b32 s28, s6
s_mov_b32 s29, s7
s_mov_b32 s30, 60000
s_mov_b32 s31, 0x00020000
s_mov_b32 s32, s8
s_mov_b32 s33, s9
s_mov_b32 s34, 1280000
s_mov_b32 s35, 0x00020000
s_mov_b32 s36, s10
s_mov_b32 s37, s11
s_mov_b32 s38, 640000
s_mov_b32 s39, 0x00020000
s_add_u32 s40, s24, 0
s_addc_u32 s41, s25, 0
s_mov_b32 s42, 10240000
s_mov_b32 s43, 0x00020000
s_add_u32 s44, s24, 11534336
s_addc_u32 s45, s25, 0
s_mov_b32 s46, 2560000
s_mov_b32 s47, 0x00020000
s_mov_b32 s48, s14
s_mov_b32 s49, s15
s_mov_b32 s50, 66816
s_mov_b32 s51, 0x00020000
s_mov_b32 s52, s16
s_mov_b32 s53, s17
s_mov_b32 s54, 256
s_mov_b32 s55, 0x00020000
s_add_u32 s56, s24, 14680064
s_addc_u32 s57, s25, 0
s_mov_b32 s58, 2560000
s_mov_b32 s59, 0x00020000
s_add_u32 s60, s20, 2560000
s_addc_u32 s61, s21, 0
s_mov_b32 s62, 60000
s_mov_b32 s63, 0x00020000
s_add_u32 s64, s24, 10485760
s_addc_u32 s65, s25, 0
s_mov_b32 s66, 320256
s_mov_b32 s67, 0x00020000
s_mov_b32 s68, s12
s_mov_b32 s69, s13
s_mov_b32 s70, 640000
s_mov_b32 s71, 0x00020000
v_and_b32 v1, 63, v0
v_lshrrev_b32 v2, 6, v0
v_and_b32 v3, 31, v1
v_lshrrev_b32 v4, 5, v1
s_nop 0
v_readfirstlane_b32 s72, v2
s_lshl_b32 s3, s2, 8
v_lshl_add_u32 v5, v1, 2, s3
buffer_load_dword v6, v5, s[64:67], 0 offen
buffer_load_dword v7, v5, s[64:67], 0 offen offset:256
s_lshl_b32 s73, s72, 5
v_add_u32 v8, s73, v3
v_lshlrev_b32 v9, 1, v8
v_add_u32 v9, 65536, v9
buffer_load_ushort v100, v9, s[48:51], 0 offen offset:0
buffer_load_ushort v101, v9, s[48:51], 0 offen offset:256
buffer_load_ushort v102, v9, s[48:51], 0 offen offset:512
buffer_load_ushort v103, v9, s[48:51], 0 offen offset:768
buffer_load_ushort v104, v9, s[48:51], 0 offen offset:1024
s_lshl_b32 s74, s2, 13
v_lshl_add_u32 v9, v8, 2, s74
buffer_load_dword v108, v9, s[40:43], 0 offen offset:0
buffer_load_dword v109, v9, s[40:43], 0 offen offset:1024
buffer_load_dword v110, v9, s[40:43], 0 offen offset:2048
buffer_load_dword v111, v9, s[40:43], 0 offen offset:3072
v_add_u32 v10, 4096, v9
buffer_load_dword v112, v10, s[40:43], 0 offen offset:0
v_add_u32 v10, 4096, v9
buffer_load_dword v113, v10, s[40:43], 0 offen offset:1024
v_add_u32 v10, 4096, v9
buffer_load_dword v114, v10, s[40:43], 0 offen offset:2048
v_add_u32 v10, 4096, v9
buffer_load_dword v115, v10, s[40:43], 0 offen offset:3072
v_lshlrev_b32 v9, 1, v1
buffer_load_ushort v96, v9, s[52:55], 0 offen
buffer_load_ushort v97, v9, s[52:55], 0 offen offset:128
s_lshl_b32 s84, s2, 3
v_and_b32 v99, 7, v1
v_add_u32 v99, s84, v99
v_mul_u32_u24 v99, 6, v99
v_bfe_u32 v9, v1, 3, 2
v_add_u32 v9, -1, v9
v_max_i32 v9, 0, v9
v_lshl_add_u32 v99, v9, 1, v99
buffer_load_ushort v98, v99, s[28:31], 0 offen
s_waitcnt vmcnt(0)
v_lshlrev_b32 v96, 16, v96
v_lshlrev_b32 v97, 16, v97
v_lshlrev_b32 v9, 2, v1
ds_write_b32 v9, v96 offset:26624
ds_write_b32 v9, v97 offset:26880
v_sub_u32 v7, v7, v6
v_mov_b32 v10, v7
v_subrev_u32 v11, 1, v1
v_max_i32 v11, 0, v11
v_lshlrev_b32 v11, 2, v11
ds_bpermute_b32 v12, v11, v10
s_waitcnt lgkmcnt(0)
v_cmp_le_u32 vcc, 1, v1
s_nop 1
v_cndmask_b32 v12, 0, v12, vcc
v_add_u32 v10, v10, v12
v_subrev_u32 v11, 2, v1
v_max_i32 v11, 0, v11
v_lshlrev_b32 v11, 2, v11
ds_bpermute_b32 v12, v11, v10
s_waitcnt lgkmcnt(0)
v_cmp_le_u32 vcc, 2, v1
s_nop 1
v_cndmask_b32 v12, 0, v12, vcc
v_add_u32 v10, v10, v12
v_subrev_u32 v11, 4, v1
v_max_i32 v11, 0, v11
v_lshlrev_b32 v11, 2, v11
ds_bpermute_b32 v12, v11, v10
s_waitcnt lgkmcnt(0)
v_cmp_le_u32 vcc, 4, v1
s_nop 1
v_cndmask_b32 v12, 0, v12, vcc
v_add_u32 v10, v10, v12
v_subrev_u32 v11, 8, v1
v_max_i32 v11, 0, v11
v_lshlrev_b32 v11, 2, v11
ds_bpermute_b32 v12, v11, v10
s_waitcnt lgkmcnt(0)
v_cmp_le_u32 vcc, 8, v1
s_nop 1
v_cndmask_b32 v12, 0, v12, vcc
v_add_u32 v10, v10, v12
v_subrev_u32 v11, 16, v1
v_max_i32 v11, 0, v11
v_lshlrev_b32 v11, 2, v11
ds_bpermute_b32 v12, v11, v10
s_waitcnt lgkmcnt(0)
v_cmp_le_u32 vcc, 16, v1
s_nop 1
v_cndmask_b32 v12, 0, v12, vcc
v_add_u32 v10, v10, v12
v_subrev_u32 v11, 32, v1
v_max_i32 v11, 0, v11
v_lshlrev_b32 v11, 2, v11
ds_bpermute_b32 v12, v11, v10
s_waitcnt lgkmcnt(0)
v_cmp_le_u32 vcc, 32, v1
s_nop 1
v_cndmask_b32 v12, 0, v12, vcc
v_add_u32 v10, v10, v12
s_nop 0
v_readlane_b32 s75, v10, 63
v_sub_u32 v10, v10, v7
v_lshlrev_b32 v11, 2, v1
ds_write_b32 v11, v10
ds_write_b32 v11, v6 offset:256
v_mov_b32 v12, 0
ds_write_b32 v11, v12 offset:512
v_mov_b32 v64, 0
v_mov_b32 v65, 0
v_mov_b32 v66, 0
v_mov_b32 v67, 0
v_mov_b32 v68, 0
v_mov_b32 v69, 0
v_mov_b32 v70, 0
v_mov_b32 v71, 0
v_mov_b32 v72, 0
v_mov_b32 v73, 0
v_mov_b32 v74, 0
v_mov_b32 v75, 0
v_mov_b32 v76, 0
v_mov_b32 v77, 0
v_mov_b32 v78, 0
v_mov_b32 v79, 0
v_lshl_or_b32 v120, v101, 16, v100
v_lshl_or_b32 v121, v103, 16, v102
v_mov_b32 v122, v104
v_mov_b32 v123, 0
v_cvt_pk_bf16_f32 v100, v108, v108
v_lshlrev_b32 v13, 16, v100
v_sub_f32 v108, v108, v13
v_and_b32 v100, 0xffff, v100
v_cvt_pk_bf16_f32 v101, v109, v109
v_lshlrev_b32 v13, 16, v101
v_sub_f32 v109, v109, v13
v_and_b32 v101, 0xffff, v101
v_cvt_pk_bf16_f32 v102, v110, v110
v_lshlrev_b32 v13, 16, v102
v_sub_f32 v110, v110, v13
v_and_b32 v102, 0xffff, v102
v_cvt_pk_bf16_f32 v103, v111, v111
v_lshlrev_b32 v13, 16, v103
v_sub_f32 v111, v111, v13
v_and_b32 v103, 0xffff, v103
v_cvt_pk_bf16_f32 v104, v112, v112
v_lshlrev_b32 v13, 16, v104
v_sub_f32 v112, v112, v13
v_and_b32 v104, 0xffff, v104
v_cvt_pk_bf16_f32 v105, v113, v113
v_lshlrev_b32 v13, 16, v105
v_sub_f32 v113, v113, v13
v_and_b32 v105, 0xffff, v105
v_cvt_pk_bf16_f32 v106, v114, v114
v_lshlrev_b32 v13, 16, v106
v_sub_f32 v114, v114, v13
v_and_b32 v106, 0xffff, v106
v_cvt_pk_bf16_f32 v107, v115, v115
v_lshlrev_b32 v13, 16, v107
v_sub_f32 v115, v115, v13
v_and_b32 v107, 0xffff, v107
v_lshl_or_b32 v13, v101, 16, v100
v_cvt_pk_bf16_f32 v14, v108, v109
v_cmp_eq_u32 vcc, 1, v4
s_nop 1
v_cndmask_b32 v120, v120, v13, vcc
v_cndmask_b32 v124, 0, v14, vcc
v_lshl_or_b32 v13, v103, 16, v102
v_cvt_pk_bf16_f32 v14, v110, v111
v_cmp_eq_u32 vcc, 1, v4
s_nop 1
v_cndmask_b32 v121, v121, v13, vcc
v_cndmask_b32 v125, 0, v14, vcc
v_lshl_or_b32 v13, v105, 16, v104
v_cvt_pk_bf16_f32 v14, v112, v113
v_cmp_eq_u32 vcc, 1, v4
s_nop 1
v_cndmask_b32 v122, v122, v13, vcc
v_cndmask_b32 v126, 0, v14, vcc
v_lshl_or_b32 v13, v107, 16, v106
v_cvt_pk_bf16_f32 v14, v114, v115
v_cmp_eq_u32 vcc, 1, v4
s_nop 1
v_cndmask_b32 v123, v123, v13, vcc
v_cndmask_b32 v127, 0, v14, vcc
v_lshl_add_u32 v15, v3, 2, 0
s_lshl_b32 s73, s72, 7
v_add_u32 v15, s73, v15
s_mov_b32 s76, 0
kb_batch:
s_cmp_ge_u32 s76, s75
s_cbranch_scc1 kb_fin
s_waitcnt lgkmcnt(0)
s_barrier
v_mov_b32 v16, 0
v_mov_b32 v17, 0
v_mov_b32 v18, 0
v_mov_b32 v19, 0
v_lshlrev_b32 v20, 6, v0
ds_write_b128 v20, v[16:19] offset:10240
ds_write_b128 v20, v[16:19] offset:10256
ds_write_b128 v20, v[16:19] offset:10272
ds_write_b128 v20, v[16:19] offset:10288
v_add_u32 v21, s76, v0
v_mov_b32 v22, 0
v_add_u32 v23, 32, v22
v_lshlrev_b32 v24, 2, v23
ds_read_b32 v25, v24
s_waitcnt lgkmcnt(0)
v_cmp_le_u32 vcc, v25, v21
s_nop 1
v_cndmask_b32 v22, v22, v23, vcc
v_add_u32 v23, 16, v22
v_lshlrev_b32 v24, 2, v23
ds_read_b32 v25, v24
s_waitcnt lgkmcnt(0)
v_cmp_le_u32 vcc, v25, v21
s_nop 1
v_cndmask_b32 v22, v22, v23, vcc
v_add_u32 v23, 8, v22
v_lshlrev_b32 v24, 2, v23
ds_read_b32 v25, v24
s_waitcnt lgkmcnt(0)
v_cmp_le_u32 vcc, v25, v21
s_nop 1
v_cndmask_b32 v22, v22, v23, vcc
v_add_u32 v23, 4, v22
v_lshlrev_b32 v24, 2, v23
ds_read_b32 v25, v24
s_waitcnt lgkmcnt(0)
v_cmp_le_u32 vcc, v25, v21
s_nop 1
v_cndmask_b32 v22, v22, v23, vcc
v_add_u32 v23, 2, v22
v_lshlrev_b32 v24, 2, v23
ds_read_b32 v25, v24
s_waitcnt lgkmcnt(0)
v_cmp_le_u32 vcc, v25, v21
s_nop 1
v_cndmask_b32 v22, v22, v23, vcc
v_add_u32 v23, 1, v22
v_lshlrev_b32 v24, 2, v23
ds_read_b32 v25, v24
s_waitcnt lgkmcnt(0)
v_cmp_le_u32 vcc, v25, v21
s_nop 1
v_cndmask_b32 v22, v22, v23, vcc
v_lshlrev_b32 v24, 2, v22
ds_read_b32 v25, v24
ds_read_b32 v26, v24 offset:256
s_waitcnt lgkmcnt(0)
v_sub_u32 v25, v21, v25
v_add_u32 v25, v25, v26
v_mul_u32_u24 v26, 2500, v22
v_add_lshl_u32 v25, v25, v26, 4
v_cmp_gt_u32 vcc, s75, v21
s_nop 1
v_cndmask_b32 v25, -16, v25, vcc
buffer_load_dwordx4 v[28:31], v25, s[44:47], 0 offen
s_waitcnt vmcnt(0)
v_mul_u32_u24 v25, 6, v28
v_mul_u32_u24 v26, 6, v29
buffer_load_ushort v32, v25, s[28:31], 0 offen offset:0
buffer_load_ushort v35, v26, s[28:31], 0 offen offset:0
buffer_load_ushort v33, v25, s[28:31], 0 offen offset:2
buffer_load_ushort v36, v26, s[28:31], 0 offen offset:2
buffer_load_ushort v34, v25, s[28:31], 0 offen offset:4
buffer_load_ushort v37, v26, s[28:31], 0 offen offset:4
s_waitcnt vmcnt(0)
v_lshlrev_b32 v32, 16, v32
v_lshlrev_b32 v35, 16, v35
v_sub_f32 v32, v35, v32
v_cvt_pk_bf16_f32 v32, v32, v32
v_lshlrev_b32 v32, 16, v32
v_mul_f32 v35, v32, v32
v_cvt_pk_bf16_f32 v35, v35, v35
v_lshlrev_b32 v35, 16, v35
v_lshlrev_b32 v33, 16, v33
v_lshlrev_b32 v36, 16, v36
v_sub_f32 v33, v36, v33
v_cvt_pk_bf16_f32 v33, v33, v33
v_lshlrev_b32 v33, 16, v33
v_mul_f32 v36, v33, v33
v_cvt_pk_bf16_f32 v36, v36, v36
v_lshlrev_b32 v36, 16, v36
v_lshlrev_b32 v34, 16, v34
v_lshlrev_b32 v37, 16, v37
v_sub_f32 v34, v37, v34
v_cvt_pk_bf16_f32 v34, v34, v34
v_lshlrev_b32 v34, 16, v34
v_mul_f32 v37, v34, v34
v_cvt_pk_bf16_f32 v37, v37, v37
v_lshlrev_b32 v37, 16, v37
v_add_f32 v35, v35, v36
v_add_f32 v35, v35, v37
v_cvt_pk_bf16_f32 v35, v35, v35
v_and_b32 v35, 0xffff, v35
v_lshl_or_b32 v40, v30, 16, v35
v_lshrrev_b32 v41, 16, v30
v_lshl_or_b32 v41, v31, 16, v41
v_lshrrev_b32 v42, 16, v31
v_mov_b32 v43, 0
v_and_b32 v29, 7, v29
v_mov_b32 v46, 0x3f80
v_mov_b32 v47, 0x3f800000
v_cmp_eq_u32 vcc, 0, v29
s_nop 1
v_cndmask_b32 v48, 0, v46, vcc
v_cmp_eq_u32 vcc, 1, v29
s_nop 1
v_cndmask_b32 v48, v48, v47, vcc
v_mov_b32 v46, 0x3f80
v_mov_b32 v47, 0x3f800000
v_cmp_eq_u32 vcc, 2, v29
s_nop 1
v_cndmask_b32 v49, 0, v46, vcc
v_cmp_eq_u32 vcc, 3, v29
s_nop 1
v_cndmask_b32 v49, v49, v47, vcc
v_mov_b32 v46, 0x3f80
v_mov_b32 v47, 0x3f800000
v_cmp_eq_u32 vcc, 4, v29
s_nop 1
v_cndmask_b32 v50, 0, v46, vcc
v_cmp_eq_u32 vcc, 5, v29
s_nop 1
v_cndmask_b32 v50, v50, v47, vcc
v_mov_b32 v46, 0x3f80
v_mov_b32 v47, 0x3f800000
v_cmp_eq_u32 vcc, 6, v29
s_nop 1
v_cndmask_b32 v51, 0, v46, vcc
v_cmp_eq_u32 vcc, 7, v29
s_nop 1
v_cndmask_b32 v51, v51, v47, vcc
v_cmp_gt_u32 vcc, s75, v21
s_nop 1
v_cndmask_b32 v40, 0, v40, vcc
v_cndmask_b32 v41, 0, v41, vcc
v_cndmask_b32 v42, 0, v42, vcc
v_cndmask_b32 v48, 0, v48, vcc
v_cndmask_b32 v49, 0, v49, vcc
v_cndmask_b32 v50, 0, v50, vcc
v_cndmask_b32 v51, 0, v51, vcc
v_lshlrev_b32 v28, 10, v28
v_add_u32 v28, 512, v28
v_cndmask_b32 v28, 0, v28, vcc
v_lshlrev_b32 v20, 5, v0
ds_write_b128 v20, v[40:43] offset:2048
ds_write_b128 v20, v[48:51] offset:2064
v_lshlrev_b32 v20, 2, v0
ds_write_b32 v20, v28 offset:1024
v_and_b32 v20, 31, v0
v_and_b32 v22, 3, v20
v_bfe_u32 v23, v20, 2, 1
v_lshl_add_u32 v22, v23, 3, v22
v_bfe_u32 v23, v20, 3, 1
v_lshl_add_u32 v22, v23, 2, v22
v_bfe_u32 v23, v20, 4, 1
v_lshl_add_u32 v22, v23, 4, v22
v_lshrrev_b32 v23, 5, v0
v_lshlrev_b32 v23, 11, v23
v_lshl_add_u32 v23, v22, 1, v23
v_lshl_add_u32 v23, v29, 6, v23
s_waitcnt lgkmcnt(0)
s_barrier
s_and_saveexec_b64 s[78:79], vcc
v_mov_b32 v46, 0x3f80
ds_write_b16 v23, v46 offset:10240
v_lshrrev_b32 v46, 16, v32
ds_write_b16 v23, v46 offset:10752
v_lshrrev_b32 v46, 16, v33
ds_write_b16 v23, v46 offset:11264
v_lshrrev_b32 v46, 16, v34
ds_write_b16 v23, v46 offset:11776
s_mov_b64 exec, -1
s_waitcnt lgkmcnt(0)
s_barrier
s_sub_u32 s77, s75, s76
s_min_u32 s77, s77, 256
s_add_u32 s77, s77, 31
s_lshr_b32 s77, s77, 5
s_mov_b32 s80, 0
v_lshlrev_b32 v20, 4, v4
v_lshlrev_b32 v21, 5, v3
v_add_u32 v21, v21, v20
v_lshlrev_b32 v22, 6, v3
v_add_u32 v22, v22, v20
ds_read_b128 v[128:131], v20 offset:1024
ds_read_b128 v[132:135], v20 offset:1056
ds_read_b128 v[136:139], v20 offset:1088
ds_read_b128 v[140:143], v20 offset:1120
s_waitcnt lgkmcnt(0)
v_add_u32 v128, v128, v15
buffer_load_dword v128, v128, s[40:43], 0 offen
v_add_u32 v129, v129, v15
buffer_load_dword v129, v129, s[40:43], 0 offen
v_add_u32 v130, v130, v15
buffer_load_dword v130, v130, s[40:43], 0 offen
v_add_u32 v131, v131, v15
buffer_load_dword v131, v131, s[40:43], 0 offen
v_add_u32 v132, v132, v15
buffer_load_dword v132, v132, s[40:43], 0 offen
v_add_u32 v133, v133, v15
buffer_load_dword v133, v133, s[40:43], 0 offen
v_add_u32 v134, v134, v15
buffer_load_dword v134, v134, s[40:43], 0 offen
v_add_u32 v135, v135, v15
buffer_load_dword v135, v135, s[40:43], 0 offen
v_add_u32 v136, v136, v15
buffer_load_dword v136, v136, s[40:43], 0 offen
v_add_u32 v137, v137, v15
buffer_load_dword v137, v137, s[40:43], 0 offen
v_add_u32 v138, v138, v15
buffer_load_dword v138, v138, s[40:43], 0 offen
v_add_u32 v139, v139, v15
buffer_load_dword v139, v139, s[40:43], 0 offen
v_add_u32 v140, v140, v15
buffer_load_dword v140, v140, s[40:43], 0 offen
v_add_u32 v141, v141, v15
buffer_load_dword v141, v141, s[40:43], 0 offen
v_add_u32 v142, v142, v15
buffer_load_dword v142, v142, s[40:43], 0 offen
v_add_u32 v143, v143, v15
buffer_load_dword v143, v143, s[40:43], 0 offen
v_add_u32 v20, 128, v20
kb_loop:
s_waitcnt vmcnt(0)
v_mov_b32 v32, v128
v_mov_b32 v33, v129
v_mov_b32 v34, v130
v_mov_b32 v35, v131
v_mov_b32 v36, v132
v_mov_b32 v37, v133
v_mov_b32 v38, v134
v_mov_b32 v39, v135
v_mov_b32 v40, v136
v_mov_b32 v41, v137
v_mov_b32 v42, v138
v_mov_b32 v43, v139
v_mov_b32 v44, v140
v_mov_b32 v45, v141
v_mov_b32 v46, v142
v_mov_b32 v47, v143
s_add_u32 s80, s80, 1
s_cmp_ge_u32 s80, s77
s_cbranch_scc1 kb_ni
ds_read_b128 v[128:131], v20 offset:1024
ds_read_b128 v[132:135], v20 offset:1056
ds_read_b128 v[136:139], v20 offset:1088
ds_read_b128 v[140:143], v20 offset:1120
s_waitcnt lgkmcnt(0)
v_add_u32 v128, v128, v15
buffer_load_dword v128, v128, s[40:43], 0 offen
v_add_u32 v129, v129, v15
buffer_load_dword v129, v129, s[40:43], 0 offen
v_add_u32 v130, v130, v15
buffer_load_dword v130, v130, s[40:43], 0 offen
v_add_u32 v131, v131, v15
buffer_load_dword v131, v131, s[40:43], 0 offen
v_add_u32 v132, v132, v15
buffer_load_dword v132, v132, s[40:43], 0 offen
v_add_u32 v133, v133, v15
buffer_load_dword v133, v133, s[40:43], 0 offen
v_add_u32 v134, v134, v15
buffer_load_dword v134, v134, s[40:43], 0 offen
v_add_u32 v135, v135, v15
buffer_load_dword v135, v135, s[40:43], 0 offen
v_add_u32 v136, v136, v15
buffer_load_dword v136, v136, s[40:43], 0 offen
v_add_u32 v137, v137, v15
buffer_load_dword v137, v137, s[40:43], 0 offen
v_add_u32 v138, v138, v15
buffer_load_dword v138, v138, s[40:43], 0 offen
v_add_u32 v139, v139, v15
buffer_load_dword v139, v139, s[40:43], 0 offen
v_add_u32 v140, v140, v15
buffer_load_dword v140, v140, s[40:43], 0 offen
v_add_u32 v141, v141, v15
buffer_load_dword v141, v141, s[40:43], 0 offen
v_add_u32 v142, v142, v15
buffer_load_dword v142, v142, s[40:43], 0 offen
v_add_u32 v143, v143, v15
buffer_load_dword v143, v143, s[40:43], 0 offen
v_add_u32 v20, 128, v20
kb_ni:
ds_read_b128 v[24:27], v21 offset:2048
ds_read_b128 v[48:51], v22 offset:10240
ds_read_b128 v[52:55], v22 offset:10272
s_waitcnt vmcnt(63) lgkmcnt(0)
v_mfma_f32_32x32x16_bf16 v[32:47], v[24:27], v[120:123], v[32:47]
v_mfma_f32_32x32x16_bf16 v[32:47], v[24:27], v[124:127], v[32:47]
s_nop 15
s_nop 3
v_cvt_pk_bf16_f32 v32, v32, v32
v_lshlrev_b32 v32, 16, v32
v_mul_f32 v60, 0xbfb8aa3b, v32
v_exp_f32 v60, v60
s_nop 0
v_add_f32 v60, 1.0, v60
v_rcp_f32 v60, v60
s_nop 0
v_mul_f32 v32, v32, v60
v_cvt_pk_bf16_f32 v33, v33, v33
v_lshlrev_b32 v33, 16, v33
v_mul_f32 v61, 0xbfb8aa3b, v33
v_exp_f32 v61, v61
s_nop 0
v_add_f32 v61, 1.0, v61
v_rcp_f32 v61, v61
s_nop 0
v_mul_f32 v33, v33, v61
v_cvt_pk_bf16_f32 v34, v34, v34
v_lshlrev_b32 v34, 16, v34
v_mul_f32 v62, 0xbfb8aa3b, v34
v_exp_f32 v62, v62
s_nop 0
v_add_f32 v62, 1.0, v62
v_rcp_f32 v62, v62
s_nop 0
v_mul_f32 v34, v34, v62
v_cvt_pk_bf16_f32 v35, v35, v35
v_lshlrev_b32 v35, 16, v35
v_mul_f32 v63, 0xbfb8aa3b, v35
v_exp_f32 v63, v63
s_nop 0
v_add_f32 v63, 1.0, v63
v_rcp_f32 v63, v63
s_nop 0
v_mul_f32 v35, v35, v63
v_cvt_pk_bf16_f32 v36, v36, v36
v_lshlrev_b32 v36, 16, v36
v_mul_f32 v60, 0xbfb8aa3b, v36
v_exp_f32 v60, v60
s_nop 0
v_add_f32 v60, 1.0, v60
v_rcp_f32 v60, v60
s_nop 0
v_mul_f32 v36, v36, v60
v_cvt_pk_bf16_f32 v37, v37, v37
v_lshlrev_b32 v37, 16, v37
v_mul_f32 v61, 0xbfb8aa3b, v37
v_exp_f32 v61, v61
s_nop 0
v_add_f32 v61, 1.0, v61
v_rcp_f32 v61, v61
s_nop 0
v_mul_f32 v37, v37, v61
v_cvt_pk_bf16_f32 v38, v38, v38
v_lshlrev_b32 v38, 16, v38
v_mul_f32 v62, 0xbfb8aa3b, v38
v_exp_f32 v62, v62
s_nop 0
v_add_f32 v62, 1.0, v62
v_rcp_f32 v62, v62
s_nop 0
v_mul_f32 v38, v38, v62
v_cvt_pk_bf16_f32 v39, v39, v39
v_lshlrev_b32 v39, 16, v39
v_mul_f32 v63, 0xbfb8aa3b, v39
v_exp_f32 v63, v63
s_nop 0
v_add_f32 v63, 1.0, v63
v_rcp_f32 v63, v63
s_nop 0
v_mul_f32 v39, v39, v63
v_cvt_pk_bf16_f32 v40, v40, v40
v_lshlrev_b32 v40, 16, v40
v_mul_f32 v60, 0xbfb8aa3b, v40
v_exp_f32 v60, v60
s_nop 0
v_add_f32 v60, 1.0, v60
v_rcp_f32 v60, v60
s_nop 0
v_mul_f32 v40, v40, v60
v_cvt_pk_bf16_f32 v41, v41, v41
v_lshlrev_b32 v41, 16, v41
v_mul_f32 v61, 0xbfb8aa3b, v41
v_exp_f32 v61, v61
s_nop 0
v_add_f32 v61, 1.0, v61
v_rcp_f32 v61, v61
s_nop 0
v_mul_f32 v41, v41, v61
v_cvt_pk_bf16_f32 v42, v42, v42
v_lshlrev_b32 v42, 16, v42
v_mul_f32 v62, 0xbfb8aa3b, v42
v_exp_f32 v62, v62
s_nop 0
v_add_f32 v62, 1.0, v62
v_rcp_f32 v62, v62
s_nop 0
v_mul_f32 v42, v42, v62
v_cvt_pk_bf16_f32 v43, v43, v43
v_lshlrev_b32 v43, 16, v43
v_mul_f32 v63, 0xbfb8aa3b, v43
v_exp_f32 v63, v63
s_nop 0
v_add_f32 v63, 1.0, v63
v_rcp_f32 v63, v63
s_nop 0
v_mul_f32 v43, v43, v63
v_cvt_pk_bf16_f32 v44, v44, v44
v_lshlrev_b32 v44, 16, v44
v_mul_f32 v60, 0xbfb8aa3b, v44
v_exp_f32 v60, v60
s_nop 0
v_add_f32 v60, 1.0, v60
v_rcp_f32 v60, v60
s_nop 0
v_mul_f32 v44, v44, v60
v_cvt_pk_bf16_f32 v45, v45, v45
v_lshlrev_b32 v45, 16, v45
v_mul_f32 v61, 0xbfb8aa3b, v45
v_exp_f32 v61, v61
s_nop 0
v_add_f32 v61, 1.0, v61
v_rcp_f32 v61, v61
s_nop 0
v_mul_f32 v45, v45, v61
v_cvt_pk_bf16_f32 v46, v46, v46
v_lshlrev_b32 v46, 16, v46
v_mul_f32 v62, 0xbfb8aa3b, v46
v_exp_f32 v62, v62
s_nop 0
v_add_f32 v62, 1.0, v62
v_rcp_f32 v62, v62
s_nop 0
v_mul_f32 v46, v46, v62
v_cvt_pk_bf16_f32 v47, v47, v47
v_lshlrev_b32 v47, 16, v47
v_mul_f32 v63, 0xbfb8aa3b, v47
v_exp_f32 v63, v63
s_nop 0
v_add_f32 v63, 1.0, v63
v_rcp_f32 v63, v63
s_nop 0
v_mul_f32 v47, v47, v63
v_cvt_pk_bf16_f32 v24, v32, v33
v_cvt_pk_bf16_f32 v25, v34, v35
v_cvt_pk_bf16_f32 v26, v36, v37
v_cvt_pk_bf16_f32 v27, v38, v39
v_cvt_pk_bf16_f32 v56, v40, v41
v_cvt_pk_bf16_f32 v57, v42, v43
v_cvt_pk_bf16_f32 v58, v44, v45
v_cvt_pk_bf16_f32 v59, v46, v47
s_nop 2
v_mfma_f32_32x32x16_bf16 v[64:79], v[24:27], v[48:51], v[64:79]
v_mfma_f32_32x32x16_bf16 v[64:79], v[56:59], v[52:55], v[64:79]
v_add_u32 v21, 1024, v21
v_add_u32 v22, 2048, v22
s_nop 4
s_cmp_lt_u32 s80, s77
s_cbranch_scc1 kb_loop
s_add_u32 s76, s76, 256
s_branch kb_batch
kb_fin:
s_nop 15
s_nop 3
s_waitcnt lgkmcnt(0)
s_barrier
s_lshl_b32 s3, s2, 3
v_add_u32 v20, s3, v3
v_lshlrev_b32 v20, 8, v20
s_lshl_b32 s73, s72, 6
v_add_u32 v20, s73, v20
v_lshl_add_u32 v20, v4, 3, v20
v_cvt_pk_bf16_f32 v32, v64, v65
v_cvt_pk_bf16_f32 v33, v66, v67
v_cvt_pk_bf16_f32 v34, v68, v69
v_cvt_pk_bf16_f32 v35, v70, v71
v_cvt_pk_bf16_f32 v36, v72, v73
v_cvt_pk_bf16_f32 v37, v74, v75
v_cvt_pk_bf16_f32 v38, v76, v77
v_cvt_pk_bf16_f32 v39, v78, v79
s_lshl_b32 s73, s72, 7
v_lshl_add_u32 v9, v4, 4, s73
ds_read_b128 v[80:83], v9 offset:26624
ds_read_b128 v[84:87], v9 offset:26656
ds_read_b128 v[88:91], v9 offset:26688
ds_read_b128 v[92:95], v9 offset:26720
s_waitcnt lgkmcnt(0)
v_mul_f32 v40, v64, v80
v_fmac_f32 v40, v65, v81
v_fmac_f32 v40, v66, v82
v_fmac_f32 v40, v67, v83
v_fmac_f32 v40, v68, v84
v_fmac_f32 v40, v69, v85
v_fmac_f32 v40, v70, v86
v_fmac_f32 v40, v71, v87
v_fmac_f32 v40, v72, v88
v_fmac_f32 v40, v73, v89
v_fmac_f32 v40, v74, v90
v_fmac_f32 v40, v75, v91
v_fmac_f32 v40, v76, v92
v_fmac_f32 v40, v77, v93
v_fmac_f32 v40, v78, v94
v_fmac_f32 v40, v79, v95
v_cmp_gt_u32 vcc, 8, v3
s_and_saveexec_b64 s[78:79], vcc
buffer_store_dwordx2 v[32:33], v20, s[56:59], 0 offen offset:0
buffer_store_dwordx2 v[34:35], v20, s[56:59], 0 offen offset:16
buffer_store_dwordx2 v[36:37], v20, s[56:59], 0 offen offset:32
buffer_store_dwordx2 v[38:39], v20, s[56:59], 0 offen offset:48
s_mov_b64 exec, s[78:79]
v_lshlrev_b32 v21, 2, v3
v_cmp_le_u32 vcc, 8, v3
s_and_saveexec_b64 s[78:79], vcc
ds_add_f32 v21, v40 offset:512
s_mov_b64 exec, -1
s_waitcnt lgkmcnt(0)
s_barrier
v_cmp_le_u32 vcc, 8, v0
v_cmp_gt_u32 s[82:83], 32, v0
s_and_b64 vcc, vcc, s[82:83]
s_and_saveexec_b64 s[78:79], vcc
ds_read_b32 v22, v21 offset:512
v_mov_b32 v23, v99
v_mov_b32 v25, v98
s_waitcnt lgkmcnt(0)
v_cvt_pk_bf16_f32 v22, v22, v22
v_lshlrev_b32 v22, 16, v22
v_lshlrev_b32 v25, 16, v25
v_add_f32 v22, v25, v22
v_cvt_pk_bf16_f32 v22, v22, v22
buffer_store_short v22, v23, s[60:63], 0 offen
kb_end:
s_endpgm
.globl kc_kernel
.p2align 8
.type kc_kernel,@function
kc_kernel:
s_load_dwordx16 s[4:19], s[0:1], 0
s_load_dwordx4 s[20:23], s[0:1], 64
s_load_dwordx2 s[24:25], s[0:1], 80
s_waitcnt lgkmcnt(0)
s_cmp_ge_u32 s2, 313
s_cbranch_scc1 kc_end
s_mov_b32 s28, s4
s_mov_b32 s29, s5
s_mov_b32 s30, 2560000
s_mov_b32 s31, 0x00020000
s_add_u32 s32, s24, 14680064
s_addc_u32 s33, s25, 0
s_mov_b32 s34, 2560000
s_mov_b32 s35, 0x00020000
s_mov_b32 s36, s18
s_mov_b32 s37, s19
s_mov_b32 s38, 65536
s_mov_b32 s39, 0x00020000
s_mov_b32 s40, s20
s_mov_b32 s41, s21
s_mov_b32 s42, 2560000
s_mov_b32 s43, 0x00020000
v_and_b32 v1, 63, v0
v_lshrrev_b32 v2, 6, v0
v_and_b32 v3, 31, v1
v_lshrrev_b32 v4, 5, v1
s_lshl_b32 s3, s2, 5
v_add_u32 v5, s3, v3
v_lshlrev_b32 v6, 8, v5
v_lshl_add_u32 v6, v4, 4, v6
v_lshl_add_u32 v10, v2, 5, v3
v_lshlrev_b32 v12, 11, v4
v_lshl_add_u32 v12, v10, 1, v12
v_mov_b32 v16, 0
v_mov_b32 v17, 0
v_mov_b32 v18, 0
v_mov_b32 v19, 0
v_mov_b32 v20, 0
v_mov_b32 v21, 0
v_mov_b32 v22, 0
v_mov_b32 v23, 0
v_mov_b32 v24, 0
v_mov_b32 v25, 0
v_mov_b32 v26, 0
v_mov_b32 v27, 0
v_mov_b32 v28, 0
v_mov_b32 v29, 0
v_mov_b32 v30, 0
v_mov_b32 v31, 0
buffer_load_dwordx4 v[48:51], v6, s[28:31], 0 offen offset:0
buffer_load_dwordx4 v[52:55], v6, s[28:31], 0 offen offset:32
buffer_load_dwordx4 v[56:59], v6, s[28:31], 0 offen offset:64
buffer_load_dwordx4 v[60:63], v6, s[28:31], 0 offen offset:96
buffer_load_dwordx4 v[64:67], v6, s[28:31], 0 offen offset:128
buffer_load_dwordx4 v[68:71], v6, s[28:31], 0 offen offset:160
buffer_load_dwordx4 v[72:75], v6, s[28:31], 0 offen offset:192
buffer_load_dwordx4 v[76:79], v6, s[28:31], 0 offen offset:224
buffer_load_dwordx4 v[80:83], v6, s[32:35], 0 offen offset:0
buffer_load_dwordx4 v[84:87], v6, s[32:35], 0 offen offset:32
buffer_load_dwordx4 v[88:91], v6, s[32:35], 0 offen offset:64
buffer_load_dwordx4 v[92:95], v6, s[32:35], 0 offen offset:96
buffer_load_dwordx4 v[96:99], v6, s[32:35], 0 offen offset:128
buffer_load_dwordx4 v[100:103], v6, s[32:35], 0 offen offset:160
buffer_load_dwordx4 v[104:107], v6, s[32:35], 0 offen offset:192
buffer_load_dwordx4 v[108:111], v6, s[32:35], 0 offen offset:224
v_lshlrev_b32 v8, 4, v0
s_mov_b32 s44, 0
buffer_load_dwordx4 v[112:115], v8, s[36:39], s44 offen
s_mov_b32 s44, 4096
buffer_load_dwordx4 v[116:119], v8, s[36:39], s44 offen
s_mov_b32 s44, 8192
buffer_load_dwordx4 v[120:123], v8, s[36:39], s44 offen
s_mov_b32 s44, 12288
buffer_load_dwordx4 v[124:127], v8, s[36:39], s44 offen
s_mov_b32 s44, 16384
buffer_load_dwordx4 v[128:131], v8, s[36:39], s44 offen
s_mov_b32 s44, 20480
buffer_load_dwordx4 v[132:135], v8, s[36:39], s44 offen
s_mov_b32 s44, 24576
buffer_load_dwordx4 v[136:139], v8, s[36:39], s44 offen
s_mov_b32 s44, 28672
buffer_load_dwordx4 v[140:143], v8, s[36:39], s44 offen
s_mov_b32 s44, 32768
buffer_load_dwordx4 v[144:147], v8, s[36:39], s44 offen
s_mov_b32 s44, 36864
buffer_load_dwordx4 v[148:151], v8, s[36:39], s44 offen
s_mov_b32 s44, 40960
buffer_load_dwordx4 v[152:155], v8, s[36:39], s44 offen
s_mov_b32 s44, 45056
buffer_load_dwordx4 v[156:159], v8, s[36:39], s44 offen
s_mov_b32 s44, 49152
buffer_load_dwordx4 v[160:163], v8, s[36:39], s44 offen
s_mov_b32 s44, 53248
buffer_load_dwordx4 v[164:167], v8, s[36:39], s44 offen
s_mov_b32 s44, 57344
buffer_load_dwordx4 v[168:171], v8, s[36:39], s44 offen
s_mov_b32 s44, 61440
buffer_load_dwordx4 v[172:175], v8, s[36:39], s44 offen
s_waitcnt vmcnt(0)
ds_write_b128 v8, v[112:115] offset:0
ds_write_b128 v8, v[116:119] offset:4096
ds_write_b128 v8, v[120:123] offset:8192
ds_write_b128 v8, v[124:127] offset:12288
ds_write_b128 v8, v[128:131] offset:16384
ds_write_b128 v8, v[132:135] offset:20480
ds_write_b128 v8, v[136:139] offset:24576
ds_write_b128 v8, v[140:143] offset:28672
ds_write_b128 v8, v[144:147] offset:32768
ds_write_b128 v8, v[148:151] offset:36864
ds_write_b128 v8, v[152:155] offset:40960
ds_write_b128 v8, v[156:159] offset:45056
ds_write_b128 v8, v[160:163] offset:49152
ds_write_b128 v8, v[164:167] offset:53248
ds_write_b128 v8, v[168:171] offset:57344
ds_write_b128 v8, v[172:175] offset:61440
v_bfe_u32 v9, v1, 2, 2
v_lshl_add_u32 v9, v4, 3, v9
v_lshlrev_b32 v9, 8, v9
v_bfe_u32 v14, v1, 4, 1
v_lshl_add_u32 v9, v14, 5, v9
v_and_b32 v14, 3, v1
v_lshl_add_u32 v9, v14, 3, v9
s_waitcnt lgkmcnt(0)
s_barrier
v_lshl_add_u32 v8, v2, 6, v9
v_add_u32 v8, 0, v8
ds_read_b64_tr_b16 v[112:113], v8 offset:0
ds_read_b64_tr_b16 v[114:115], v8 offset:1024
ds_read_b64_tr_b16 v[116:117], v8 offset:4096
ds_read_b64_tr_b16 v[118:119], v8 offset:5120
ds_read_b64_tr_b16 v[120:121], v8 offset:8192
ds_read_b64_tr_b16 v[122:123], v8 offset:9216
ds_read_b64_tr_b16 v[124:125], v8 offset:12288
ds_read_b64_tr_b16 v[126:127], v8 offset:13312
ds_read_b64_tr_b16 v[128:129], v8 offset:16384
ds_read_b64_tr_b16 v[130:131], v8 offset:17408
ds_read_b64_tr_b16 v[132:133], v8 offset:20480
ds_read_b64_tr_b16 v[134:135], v8 offset:21504
ds_read_b64_tr_b16 v[136:137], v8 offset:24576
ds_read_b64_tr_b16 v[138:139], v8 offset:25600
ds_read_b64_tr_b16 v[140:141], v8 offset:28672
ds_read_b64_tr_b16 v[142:143], v8 offset:29696
s_waitcnt vmcnt(0) lgkmcnt(0)
v_mfma_f32_32x32x16_bf16 v[16:31], v[48:51], v[112:115], v[16:31]
v_mfma_f32_32x32x16_bf16 v[16:31], v[52:55], v[116:119], v[16:31]
v_mfma_f32_32x32x16_bf16 v[16:31], v[56:59], v[120:123], v[16:31]
v_mfma_f32_32x32x16_bf16 v[16:31], v[60:63], v[124:127], v[16:31]
v_mfma_f32_32x32x16_bf16 v[16:31], v[64:67], v[128:131], v[16:31]
v_mfma_f32_32x32x16_bf16 v[16:31], v[68:71], v[132:135], v[16:31]
v_mfma_f32_32x32x16_bf16 v[16:31], v[72:75], v[136:139], v[16:31]
v_mfma_f32_32x32x16_bf16 v[16:31], v[76:79], v[140:143], v[16:31]
s_nop 15
v_lshl_add_u32 v8, v2, 6, v9
v_add_u32 v8, 32768, v8
ds_read_b64_tr_b16 v[112:113], v8 offset:0
ds_read_b64_tr_b16 v[114:115], v8 offset:1024
ds_read_b64_tr_b16 v[116:117], v8 offset:4096
ds_read_b64_tr_b16 v[118:119], v8 offset:5120
ds_read_b64_tr_b16 v[120:121], v8 offset:8192
ds_read_b64_tr_b16 v[122:123], v8 offset:9216
ds_read_b64_tr_b16 v[124:125], v8 offset:12288
ds_read_b64_tr_b16 v[126:127], v8 offset:13312
ds_read_b64_tr_b16 v[128:129], v8 offset:16384
ds_read_b64_tr_b16 v[130:131], v8 offset:17408
ds_read_b64_tr_b16 v[132:133], v8 offset:20480
ds_read_b64_tr_b16 v[134:135], v8 offset:21504
ds_read_b64_tr_b16 v[136:137], v8 offset:24576
ds_read_b64_tr_b16 v[138:139], v8 offset:25600
ds_read_b64_tr_b16 v[140:141], v8 offset:28672
ds_read_b64_tr_b16 v[142:143], v8 offset:29696
s_waitcnt vmcnt(0) lgkmcnt(0)
v_mfma_f32_32x32x16_bf16 v[16:31], v[80:83], v[112:115], v[16:31]
v_mfma_f32_32x32x16_bf16 v[16:31], v[84:87], v[116:119], v[16:31]
v_mfma_f32_32x32x16_bf16 v[16:31], v[88:91], v[120:123], v[16:31]
v_mfma_f32_32x32x16_bf16 v[16:31], v[92:95], v[124:127], v[16:31]
v_mfma_f32_32x32x16_bf16 v[16:31], v[96:99], v[128:131], v[16:31]
v_mfma_f32_32x32x16_bf16 v[16:31], v[100:103], v[132:135], v[16:31]
v_mfma_f32_32x32x16_bf16 v[16:31], v[104:107], v[136:139], v[16:31]
v_mfma_f32_32x32x16_bf16 v[16:31], v[108:111], v[140:143], v[16:31]
s_nop 15
s_nop 15
v_lshl_add_u32 v48, v4, 2, 0
v_add_u32 v48, s3, v48
v_lshlrev_b32 v48, 8, v48
v_lshl_add_u32 v48, v10, 1, v48
buffer_load_ushort v64, v48, s[28:31], 0 offen
v_lshl_add_u32 v49, v4, 2, 1
v_add_u32 v49, s3, v49
v_lshlrev_b32 v49, 8, v49
v_lshl_add_u32 v49, v10, 1, v49
buffer_load_ushort v65, v49, s[28:31], 0 offen
v_lshl_add_u32 v50, v4, 2, 2
v_add_u32 v50, s3, v50
v_lshlrev_b32 v50, 8, v50
v_lshl_add_u32 v50, v10, 1, v50
buffer_load_ushort v66, v50, s[28:31], 0 offen
v_lshl_add_u32 v51, v4, 2, 3
v_add_u32 v51, s3, v51
v_lshlrev_b32 v51, 8, v51
v_lshl_add_u32 v51, v10, 1, v51
buffer_load_ushort v67, v51, s[28:31], 0 offen
v_lshl_add_u32 v52, v4, 2, 8
v_add_u32 v52, s3, v52
v_lshlrev_b32 v52, 8, v52
v_lshl_add_u32 v52, v10, 1, v52
buffer_load_ushort v68, v52, s[28:31], 0 offen
v_lshl_add_u32 v53, v4, 2, 9
v_add_u32 v53, s3, v53
v_lshlrev_b32 v53, 8, v53
v_lshl_add_u32 v53, v10, 1, v53
buffer_load_ushort v69, v53, s[28:31], 0 offen
v_lshl_add_u32 v54, v4, 2, 10
v_add_u32 v54, s3, v54
v_lshlrev_b32 v54, 8, v54
v_lshl_add_u32 v54, v10, 1, v54
buffer_load_ushort v70, v54, s[28:31], 0 offen
v_lshl_add_u32 v55, v4, 2, 11
v_add_u32 v55, s3, v55
v_lshlrev_b32 v55, 8, v55
v_lshl_add_u32 v55, v10, 1, v55
buffer_load_ushort v71, v55, s[28:31], 0 offen
v_lshl_add_u32 v56, v4, 2, 16
v_add_u32 v56, s3, v56
v_lshlrev_b32 v56, 8, v56
v_lshl_add_u32 v56, v10, 1, v56
buffer_load_ushort v72, v56, s[28:31], 0 offen
v_lshl_add_u32 v57, v4, 2, 17
v_add_u32 v57, s3, v57
v_lshlrev_b32 v57, 8, v57
v_lshl_add_u32 v57, v10, 1, v57
buffer_load_ushort v73, v57, s[28:31], 0 offen
v_lshl_add_u32 v58, v4, 2, 18
v_add_u32 v58, s3, v58
v_lshlrev_b32 v58, 8, v58
v_lshl_add_u32 v58, v10, 1, v58
buffer_load_ushort v74, v58, s[28:31], 0 offen
v_lshl_add_u32 v59, v4, 2, 19
v_add_u32 v59, s3, v59
v_lshlrev_b32 v59, 8, v59
v_lshl_add_u32 v59, v10, 1, v59
buffer_load_ushort v75, v59, s[28:31], 0 offen
v_lshl_add_u32 v60, v4, 2, 24
v_add_u32 v60, s3, v60
v_lshlrev_b32 v60, 8, v60
v_lshl_add_u32 v60, v10, 1, v60
buffer_load_ushort v76, v60, s[28:31], 0 offen
v_lshl_add_u32 v61, v4, 2, 25
v_add_u32 v61, s3, v61
v_lshlrev_b32 v61, 8, v61
v_lshl_add_u32 v61, v10, 1, v61
buffer_load_ushort v77, v61, s[28:31], 0 offen
v_lshl_add_u32 v62, v4, 2, 26
v_add_u32 v62, s3, v62
v_lshlrev_b32 v62, 8, v62
v_lshl_add_u32 v62, v10, 1, v62
buffer_load_ushort v78, v62, s[28:31], 0 offen
v_lshl_add_u32 v63, v4, 2, 27
v_add_u32 v63, s3, v63
v_lshlrev_b32 v63, 8, v63
v_lshl_add_u32 v63, v10, 1, v63
buffer_load_ushort v79, v63, s[28:31], 0 offen
v_cvt_pk_bf16_f32 v16, v16, v16
v_lshlrev_b32 v16, 16, v16
v_mul_f32 v14, 0xbfb8aa3b, v16
v_exp_f32 v14, v14
s_nop 0
v_add_f32 v14, 1.0, v14
v_rcp_f32 v14, v14
s_nop 0
v_mul_f32 v14, v16, v14
v_cvt_pk_bf16_f32 v14, v14, v14
v_lshlrev_b32 v14, 16, v14
s_waitcnt vmcnt(0)
v_lshlrev_b32 v9, 16, v64
v_add_f32 v14, v9, v14
v_cvt_pk_bf16_f32 v14, v14, v14
buffer_store_short v14, v48, s[40:43], 0 offen
v_cvt_pk_bf16_f32 v17, v17, v17
v_lshlrev_b32 v17, 16, v17
v_mul_f32 v14, 0xbfb8aa3b, v17
v_exp_f32 v14, v14
s_nop 0
v_add_f32 v14, 1.0, v14
v_rcp_f32 v14, v14
s_nop 0
v_mul_f32 v14, v17, v14
v_cvt_pk_bf16_f32 v14, v14, v14
v_lshlrev_b32 v14, 16, v14
v_lshlrev_b32 v9, 16, v65
v_add_f32 v14, v9, v14
v_cvt_pk_bf16_f32 v14, v14, v14
buffer_store_short v14, v49, s[40:43], 0 offen
v_cvt_pk_bf16_f32 v18, v18, v18
v_lshlrev_b32 v18, 16, v18
v_mul_f32 v14, 0xbfb8aa3b, v18
v_exp_f32 v14, v14
s_nop 0
v_add_f32 v14, 1.0, v14
v_rcp_f32 v14, v14
s_nop 0
v_mul_f32 v14, v18, v14
v_cvt_pk_bf16_f32 v14, v14, v14
v_lshlrev_b32 v14, 16, v14
v_lshlrev_b32 v9, 16, v66
v_add_f32 v14, v9, v14
v_cvt_pk_bf16_f32 v14, v14, v14
buffer_store_short v14, v50, s[40:43], 0 offen
v_cvt_pk_bf16_f32 v19, v19, v19
v_lshlrev_b32 v19, 16, v19
v_mul_f32 v14, 0xbfb8aa3b, v19
v_exp_f32 v14, v14
s_nop 0
v_add_f32 v14, 1.0, v14
v_rcp_f32 v14, v14
s_nop 0
v_mul_f32 v14, v19, v14
v_cvt_pk_bf16_f32 v14, v14, v14
v_lshlrev_b32 v14, 16, v14
v_lshlrev_b32 v9, 16, v67
v_add_f32 v14, v9, v14
v_cvt_pk_bf16_f32 v14, v14, v14
buffer_store_short v14, v51, s[40:43], 0 offen
v_cvt_pk_bf16_f32 v20, v20, v20
v_lshlrev_b32 v20, 16, v20
v_mul_f32 v14, 0xbfb8aa3b, v20
v_exp_f32 v14, v14
s_nop 0
v_add_f32 v14, 1.0, v14
v_rcp_f32 v14, v14
s_nop 0
v_mul_f32 v14, v20, v14
v_cvt_pk_bf16_f32 v14, v14, v14
v_lshlrev_b32 v14, 16, v14
v_lshlrev_b32 v9, 16, v68
v_add_f32 v14, v9, v14
v_cvt_pk_bf16_f32 v14, v14, v14
buffer_store_short v14, v52, s[40:43], 0 offen
v_cvt_pk_bf16_f32 v21, v21, v21
v_lshlrev_b32 v21, 16, v21
v_mul_f32 v14, 0xbfb8aa3b, v21
v_exp_f32 v14, v14
s_nop 0
v_add_f32 v14, 1.0, v14
v_rcp_f32 v14, v14
s_nop 0
v_mul_f32 v14, v21, v14
v_cvt_pk_bf16_f32 v14, v14, v14
v_lshlrev_b32 v14, 16, v14
v_lshlrev_b32 v9, 16, v69
v_add_f32 v14, v9, v14
v_cvt_pk_bf16_f32 v14, v14, v14
buffer_store_short v14, v53, s[40:43], 0 offen
v_cvt_pk_bf16_f32 v22, v22, v22
v_lshlrev_b32 v22, 16, v22
v_mul_f32 v14, 0xbfb8aa3b, v22
v_exp_f32 v14, v14
s_nop 0
v_add_f32 v14, 1.0, v14
v_rcp_f32 v14, v14
s_nop 0
v_mul_f32 v14, v22, v14
v_cvt_pk_bf16_f32 v14, v14, v14
v_lshlrev_b32 v14, 16, v14
v_lshlrev_b32 v9, 16, v70
v_add_f32 v14, v9, v14
v_cvt_pk_bf16_f32 v14, v14, v14
buffer_store_short v14, v54, s[40:43], 0 offen
v_cvt_pk_bf16_f32 v23, v23, v23
v_lshlrev_b32 v23, 16, v23
v_mul_f32 v14, 0xbfb8aa3b, v23
v_exp_f32 v14, v14
s_nop 0
v_add_f32 v14, 1.0, v14
v_rcp_f32 v14, v14
s_nop 0
v_mul_f32 v14, v23, v14
v_cvt_pk_bf16_f32 v14, v14, v14
v_lshlrev_b32 v14, 16, v14
v_lshlrev_b32 v9, 16, v71
v_add_f32 v14, v9, v14
v_cvt_pk_bf16_f32 v14, v14, v14
buffer_store_short v14, v55, s[40:43], 0 offen
v_cvt_pk_bf16_f32 v24, v24, v24
v_lshlrev_b32 v24, 16, v24
v_mul_f32 v14, 0xbfb8aa3b, v24
v_exp_f32 v14, v14
s_nop 0
v_add_f32 v14, 1.0, v14
v_rcp_f32 v14, v14
s_nop 0
v_mul_f32 v14, v24, v14
v_cvt_pk_bf16_f32 v14, v14, v14
v_lshlrev_b32 v14, 16, v14
v_lshlrev_b32 v9, 16, v72
v_add_f32 v14, v9, v14
v_cvt_pk_bf16_f32 v14, v14, v14
buffer_store_short v14, v56, s[40:43], 0 offen
v_cvt_pk_bf16_f32 v25, v25, v25
v_lshlrev_b32 v25, 16, v25
v_mul_f32 v14, 0xbfb8aa3b, v25
v_exp_f32 v14, v14
s_nop 0
v_add_f32 v14, 1.0, v14
v_rcp_f32 v14, v14
s_nop 0
v_mul_f32 v14, v25, v14
v_cvt_pk_bf16_f32 v14, v14, v14
v_lshlrev_b32 v14, 16, v14
v_lshlrev_b32 v9, 16, v73
v_add_f32 v14, v9, v14
v_cvt_pk_bf16_f32 v14, v14, v14
buffer_store_short v14, v57, s[40:43], 0 offen
v_cvt_pk_bf16_f32 v26, v26, v26
v_lshlrev_b32 v26, 16, v26
v_mul_f32 v14, 0xbfb8aa3b, v26
v_exp_f32 v14, v14
s_nop 0
v_add_f32 v14, 1.0, v14
v_rcp_f32 v14, v14
s_nop 0
v_mul_f32 v14, v26, v14
v_cvt_pk_bf16_f32 v14, v14, v14
v_lshlrev_b32 v14, 16, v14
v_lshlrev_b32 v9, 16, v74
v_add_f32 v14, v9, v14
v_cvt_pk_bf16_f32 v14, v14, v14
buffer_store_short v14, v58, s[40:43], 0 offen
v_cvt_pk_bf16_f32 v27, v27, v27
v_lshlrev_b32 v27, 16, v27
v_mul_f32 v14, 0xbfb8aa3b, v27
v_exp_f32 v14, v14
s_nop 0
v_add_f32 v14, 1.0, v14
v_rcp_f32 v14, v14
s_nop 0
v_mul_f32 v14, v27, v14
v_cvt_pk_bf16_f32 v14, v14, v14
v_lshlrev_b32 v14, 16, v14
v_lshlrev_b32 v9, 16, v75
v_add_f32 v14, v9, v14
v_cvt_pk_bf16_f32 v14, v14, v14
buffer_store_short v14, v59, s[40:43], 0 offen
v_cvt_pk_bf16_f32 v28, v28, v28
v_lshlrev_b32 v28, 16, v28
v_mul_f32 v14, 0xbfb8aa3b, v28
v_exp_f32 v14, v14
s_nop 0
v_add_f32 v14, 1.0, v14
v_rcp_f32 v14, v14
s_nop 0
v_mul_f32 v14, v28, v14
v_cvt_pk_bf16_f32 v14, v14, v14
v_lshlrev_b32 v14, 16, v14
v_lshlrev_b32 v9, 16, v76
v_add_f32 v14, v9, v14
v_cvt_pk_bf16_f32 v14, v14, v14
buffer_store_short v14, v60, s[40:43], 0 offen
v_cvt_pk_bf16_f32 v29, v29, v29
v_lshlrev_b32 v29, 16, v29
v_mul_f32 v14, 0xbfb8aa3b, v29
v_exp_f32 v14, v14
s_nop 0
v_add_f32 v14, 1.0, v14
v_rcp_f32 v14, v14
s_nop 0
v_mul_f32 v14, v29, v14
v_cvt_pk_bf16_f32 v14, v14, v14
v_lshlrev_b32 v14, 16, v14
v_lshlrev_b32 v9, 16, v77
v_add_f32 v14, v9, v14
v_cvt_pk_bf16_f32 v14, v14, v14
buffer_store_short v14, v61, s[40:43], 0 offen
v_cvt_pk_bf16_f32 v30, v30, v30
v_lshlrev_b32 v30, 16, v30
v_mul_f32 v14, 0xbfb8aa3b, v30
v_exp_f32 v14, v14
s_nop 0
v_add_f32 v14, 1.0, v14
v_rcp_f32 v14, v14
s_nop 0
v_mul_f32 v14, v30, v14
v_cvt_pk_bf16_f32 v14, v14, v14
v_lshlrev_b32 v14, 16, v14
v_lshlrev_b32 v9, 16, v78
v_add_f32 v14, v9, v14
v_cvt_pk_bf16_f32 v14, v14, v14
buffer_store_short v14, v62, s[40:43], 0 offen
v_cvt_pk_bf16_f32 v31, v31, v31
v_lshlrev_b32 v31, 16, v31
v_mul_f32 v14, 0xbfb8aa3b, v31
v_exp_f32 v14, v14
s_nop 0
v_add_f32 v14, 1.0, v14
v_rcp_f32 v14, v14
s_nop 0
v_mul_f32 v14, v31, v14
v_cvt_pk_bf16_f32 v14, v14, v14
v_lshlrev_b32 v14, 16, v14
v_lshlrev_b32 v9, 16, v79
v_add_f32 v14, v9, v14
v_cvt_pk_bf16_f32 v14, v14, v14
buffer_store_short v14, v63, s[40:43], 0 offen
s_endpgm
kc_end:
s_endpgm
.section .rodata,"a"
.p2align 6
.amdhsa_kernel ka_kernel
 .amdhsa_next_free_vgpr 176
 .amdhsa_next_free_sgpr 102
 .amdhsa_accum_offset 176
 .amdhsa_group_segment_fixed_size 0
 .amdhsa_kernarg_size 88
 .amdhsa_user_sgpr_count 2
 .amdhsa_user_sgpr_kernarg_segment_ptr 1
 .amdhsa_system_sgpr_workgroup_id_x 1
.end_amdhsa_kernel
.p2align 6
.amdhsa_kernel kb_kernel
 .amdhsa_next_free_vgpr 144
 .amdhsa_next_free_sgpr 102
 .amdhsa_accum_offset 144
 .amdhsa_group_segment_fixed_size 0
 .amdhsa_kernarg_size 88
 .amdhsa_user_sgpr_count 2
 .amdhsa_user_sgpr_kernarg_segment_ptr 1
 .amdhsa_system_sgpr_workgroup_id_x 1
.end_amdhsa_kernel
.p2align 6
.amdhsa_kernel kc_kernel
 .amdhsa_next_free_vgpr 176
 .amdhsa_next_free_sgpr 102
 .amdhsa_accum_offset 176
 .amdhsa_group_segment_fixed_size 0
 .amdhsa_kernarg_size 88
 .amdhsa_user_sgpr_count 2
 .amdhsa_user_sgpr_kernarg_segment_ptr 1
 .amdhsa_system_sgpr_workgroup_id_x 1
.end_amdhsa_kernel
```
